```python
import torch

def _softmax(x, axis=-1):
    return torch.softmax(x, dim=axis)
def _gelu(x):
    return torch.nn.functional.gelu(x, approximate="tanh")
def _silu(x):
    return torch.nn.functional.silu(x)
def _sigmoid(x):
    return torch.sigmoid(x)
def _layernorm(x, axis=-1, eps=1e-5):
    m = x.mean(dim=axis, keepdim=True)
    v = x.var(dim=axis, keepdim=True, unbiased=False)
    return (x - m) / torch.sqrt(v + eps)
def _scatter_add(tgt, idx, src, axis=0):
    return tgt.clone().index_add_(axis, idx, src)
def _segment_sum(src, seg, n):
    out = torch.zeros((n,) + src.shape[1:], dtype=src.dtype)
    return out.index_add_(0, seg, src)
def _pad(x, pw):
    flat = tuple(v for pair in reversed(pw) for v in pair)
    return torch.nn.functional.pad(x, flat)

kernel_name = 'parallel_sum__ssm_conv_s4d__dense_activation_squared_relu__prompt'

def setup_inputs():

    _w = (lambda a: (lambda t: t.to(torch.bfloat16) if t.is_floating_point() else t)(torch.as_tensor(a)))
    def _A_setup():
        Bsz, L, D, N = 1, 2048, 512, 128
        return {
            "u": _w((lambda *s: torch.randn(*s, dtype=torch.bfloat16) * 0.05)(Bsz, L, D)),
            "log_A_real": _w((lambda *s: torch.randn(*s, dtype=torch.bfloat16) * 3.2)(D, N) * 0.5),
            "A_imag": _w((lambda *s: torch.randn(*s, dtype=torch.bfloat16) * 0.2)(D, N) * 3.14),
            "C_real": _w((lambda *s: torch.randn(*s, dtype=torch.bfloat16) * 3.2)(D, N) / N ** 0.5),
            "C_imag": _w((lambda *s: torch.randn(*s, dtype=torch.bfloat16) * 3.2)(D, N) / N ** 0.5),
            "log_dt": _w((lambda *s: torch.randn(*s, dtype=torch.bfloat16) * 0.2)(D) * 0.5 - 4.0),
            "D_skip": _w((lambda *s: torch.randn(*s, dtype=torch.bfloat16) * 0.4)(D)),
        }
    _A_in = _A_setup()

    def _B_setup():
        B, S, D, F = 1, 2048, 512, 1376
        return {
            "x": _w((lambda *s: torch.randn(*s, dtype=torch.bfloat16) * 0.05)(B, S, D)),
            "w1": _w((lambda *s: torch.randn(*s, dtype=torch.bfloat16) * 0.05)(D, F)),
            "b1": _w((lambda *s: torch.randn(*s, dtype=torch.bfloat16) * 0.2)(F)),
            "w2": _w((lambda *s: torch.randn(*s, dtype=torch.bfloat16) * 0.05)(F, D)),
            "b2": _w((lambda *s: torch.randn(*s, dtype=torch.bfloat16) * 0.8)(D)),
        }
    _B_in = _B_setup()

    return {
        "A_u": _A_in["u"],
        "A_log_A_real": _A_in["log_A_real"],
        "A_A_imag": _A_in["A_imag"],
        "A_C_real": _A_in["C_real"],
        "A_C_imag": _A_in["C_imag"],
        "A_log_dt": _A_in["log_dt"],
        "A_D_skip": _A_in["D_skip"],
        "B_x": _B_in["x"],
        "B_w1": _B_in["w1"],
        "B_b1": _B_in["b1"],
        "B_w2": _B_in["w2"],
        "B_b2": _B_in["b2"],
    }

def reference(A_u, A_log_A_real, A_A_imag, A_C_real, A_C_imag, A_log_dt, A_D_skip, B_x, B_w1, B_b1, B_w2, B_b2):
    def _A_ref(u, log_A_real, A_imag, C_real, C_imag, log_dt, D_skip):
        L = u.shape[1]
        dt = torch.exp(log_dt)
        A = -torch.exp(log_A_real) + 1j * A_imag
        C = (C_real + 1j * C_imag) * dt[:, None]
        pos = (lambda x, dt: x.to(dt))(torch.arange(L), log_dt.dtype)
        P = torch.exp((A * dt[:, None])[:, :, None] * pos[None, None, :])
        K = 2.0 * torch.einsum("dn,dnl->dl", C, P).real
        L2 = 2 * L
        u_t = (lambda x, *d: x.permute(*d))(u, 0, 2, 1)
        Kf = (lambda x, *a, **k: torch.fft.rfft(x.float(), *a, **k))(K, L2)
        Uf = (lambda x, *a, **k: torch.fft.rfft(x.float(), *a, **k))(u_t, L2)
        y = (lambda x, *a, **k: torch.fft.irfft(x, *a, **k).to(torch.bfloat16))(Uf * Kf[None, :, :], L2)[:, :, :L]
        y = (lambda x, *d: x.permute(*d))(y, 0, 2, 1)
        return y + u * D_skip[None, None, :]

    def _B_ref(x, w1, b1, w2, b2):
        h = torch.einsum("bsd,df->bsf", x, w1) + b1
        zero = torch.zeros_like(h)
        r = torch.where(h > zero, h, zero)
        h = r * r
        out = torch.einsum("bsf,fd->bsd", h, w2) + b2
        return out

    x = A_u
    xn = _layernorm(x, axis=-1)
    return x + _A_ref(xn, A_log_A_real, A_A_imag, A_C_real, A_C_imag, A_log_dt, A_D_skip) + _B_ref(xn, B_w1, B_b1, B_w2, B_b2)
```

```asm
; @launch grid=(256,1,1) block=(768,1,1) lds=160768
.amdgcn_target "amdgcn-amd-amdhsa--gfx950"
.text
.globl parallel_sum__ssm_conv_s4d__dense_activation_squared_relu__prompt_kernel
.p2align 8
.type parallel_sum__ssm_conv_s4d__dense_activation_squared_relu__prompt_kernel,@function
parallel_sum__ssm_conv_s4d__dense_activation_squared_relu__prompt_kernel:
KF_START:
    s_cmp_ge_u32 s2, 256
    s_cbranch_scc1 KF_END
    s_load_dwordx16 s[16:31], s[0:1], 0
    s_load_dwordx8 s[32:39], s[0:1], 64
    s_load_dwordx2 s[40:41], s[0:1], 112
    s_load_dwordx4 s[60:63], s[0:1], 96
    v_lshrrev_b32 v1, 6, v0
    v_and_b32 v0, 63, v0
    v_readfirstlane_b32 s3, v1
    v_and_b32 v9, 15, v0
    v_lshrrev_b32 v10, 4, v0
    v_lshlrev_b32 v11, 4, v0
    v_mov_b32 v2, 0
    v_lshlrev_b32 v3, 2, v0
    v_add_u32 v3, 160256, v3
    ds_write_b32 v3, v2
    ds_write_b32 v3, v2 offset:256
    s_and_b32 s8, s2, 7
    s_lshr_b32 s7, s2, 3
    s_and_b32 s9, s8, 3
    s_lshl_b32 s9, s9, 3
    s_lshr_b32 s10, s7, 2
    s_add_u32 s4, s9, s10
    s_and_b32 s5, s8, 4
    s_and_b32 s10, s7, 3
    s_add_u32 s5, s5, s10
    s_mul_i32 s6, s5, 5
    s_lshr_b32 s10, s5, 1
    s_add_u32 s6, s6, s10
    s_and_b32 s67, s8, 4
    s_add_u32 s67, s67, s9
    s_lshr_b32 s10, s7, 3
    s_add_u32 s67, s67, s10
    s_xor_b32 s10, s7, s8
    s_and_b32 s10, s10, 4
    s_and_b32 s68, s7, 3
    s_add_u32 s68, s68, s10
    s_lshl_b32 s69, s8, 5
    s_add_u32 s69, s69, s7
    s_add_u32 s80, s4, s5
    s_mov_b32 s81, s68
    s_and_b32 s12, s3, 3
    v_mov_b32 v8, 160256
    s_lshl_b32 s10, s12, 2
    v_add_u32 v7, s10, v8
    v_mov_b32 v6, 1
    s_cmp_lt_u32 s3, 4
    s_cbranch_scc1 KF_A
    s_cmp_lt_u32 s3, 8
    s_cbranch_scc1 KF_L
    s_lshl_b32 s13, s6, 6
    s_mul_i32 s14, s12, 96
    s_add_u32 s13, s13, s14
    v_lshlrev_b32 v12, 3, v10
    v_add_u32 v12, s13, v12
    s_waitcnt lgkmcnt(0)
    s_mov_b32 s44, s34
    s_mov_b32 s45, s35
    s_mov_b32 s46, 0xac0
    s_mov_b32 s47, 0x00020000
    buffer_load_dwordx2 v[118:119], v12, s[44:47], 0 offen offset:0
    buffer_load_dwordx2 v[120:121], v12, s[44:47], 0 offen offset:32
    buffer_load_dwordx2 v[122:123], v12, s[44:47], 0 offen offset:64
    s_lshl_b32 s8, s68, 7
    s_add_u32 s8, s8, 64
    v_lshlrev_b32 v2, 4, v10
    v_add_u32 v2, s8, v2
    s_lshl_b32 s8, s67, 6
    s_lshl_b32 s9, s12, 4
    s_add_u32 s8, s8, s9
    v_add_u32 v3, s8, v9
    v_lshl_add_u32 v3, v3, 10, v2
    global_load_dwordx4 v[164:167], v2, s[38:39]
    s_mov_b32 s56, s40
    s_mov_b32 s57, s41
    s_mov_b32 s58, 0x10000000
    s_mov_b32 s59, 0x00020000
    s_lshl_b32 s74, s4, 9
    s_lshr_b32 s9, s5, 1
    s_lshl_b32 s9, s9, 7
    s_add_u32 s74, s74, s9
    s_and_b32 s9, s5, 1
    s_lshl_b32 s9, s9, 2
    s_add_u32 s74, s74, s9
    s_add_u32 s74, s74, 15733760
    s_lshl_b32 s75, s67, 9
    s_lshl_b32 s9, s12, 7
    s_add_u32 s75, s75, s9
    s_add_u32 s75, s75, 15733760
    s_or_b32 s79, s12, s2
    s_cmp_lg_u32 s79, 0
    s_cbranch_scc1 KF_NOCLR
    v_mov_b32 v16, 0
    v_mov_b32 v17, 0
    v_mov_b32 v18, 0
    v_mov_b32 v19, 0
    s_mov_b32 s8, 15732736
    buffer_store_dwordx4 v[16:19], v11, s[56:59], s8 offen sc1
    v_lshlrev_b32 v13, 7, v0
    s_mov_b32 s8, 15733760
    s_mov_b32 s9, 15741952
    buffer_store_dwordx2 v[16:17], v13, s[56:59], s8 offen sc1
    buffer_store_dwordx2 v[16:17], v13, s[56:59], s9 offen sc1
KF_NOCLR:
    s_barrier
    v_add_u32 v12, 0, v10
    v_xor_b32 v12, v12, v9
    v_lshlrev_b32 v12, 4, v12
    v_lshl_add_u32 v2, v9, 8, v12
    v_add_u32 v12, 4, v10
    v_xor_b32 v12, v12, v9
    v_lshlrev_b32 v12, 4, v12
    v_lshl_add_u32 v3, v9, 8, v12
    v_add_u32 v12, 8, v10
    v_xor_b32 v12, v12, v9
    v_lshlrev_b32 v12, 4, v12
    v_lshl_add_u32 v4, v9, 8, v12
    v_add_u32 v12, 12, v10
    v_xor_b32 v12, v12, v9
    v_lshlrev_b32 v12, 4, v12
    v_lshl_add_u32 v5, v9, 8, v12
    v_lshrrev_b32 v12, 2, v9
    v_lshl_add_u32 v12, v10, 2, v12
    v_bfe_u32 v13, v12, 1, 2
    v_mul_u32_u24 v12, 384, v12
    v_and_b32 v14, 3, v9
    v_lshl_add_u32 v12, v14, 3, v12
    v_add_u32 v12, 65536, v12
    s_mul_i32 s8, s12, 3
    s_add_u32 s9, s8, 0
    v_xor_b32 v14, s9, v13
    v_lshl_add_u32 v112, v14, 5, v12
    s_add_u32 s9, s8, 1
    v_xor_b32 v14, s9, v13
    v_lshl_add_u32 v113, v14, 5, v12
    s_add_u32 s9, s8, 2
    v_xor_b32 v14, s9, v13
    v_lshl_add_u32 v114, v14, 5, v12
    v_add_u32 v115, 49152, v112
    v_add_u32 v116, 49152, v113
    v_add_u32 v117, 49152, v114
    v_mov_b32 v108, 0x3f803f80
    v_mov_b32 v109, 0x3f803f80
    v_mov_b32 v110, 0x3f803f80
    v_mov_b32 v111, 0x3f803f80
    v_mov_b32 v1, 1
    s_cmp_lg_u32 s79, 0
    s_cbranch_scc1 KF_NOCNT
    s_mov_b32 s48, s62
    s_mov_b32 s49, s63
    s_mov_b32 s50, 0x100
    s_mov_b32 s51, 0x00020000
    v_mov_b32 v15, 0
    s_waitcnt vmcnt(0)
    s_mov_b64 exec, 1
    buffer_store_dword v6, v15, s[48:51], 0 offen sc1
    s_mov_b64 exec, -1
KF_NOCNT:
SPIN_1:
    s_sleep 1
    ds_read_b128 v[152:155], v8 offset:0
    s_waitcnt lgkmcnt(0)
    v_min3_u32 v152, v152, v153, v154
    v_min_u32 v152, v152, v155
    s_nop 0
    v_readfirstlane_b32 s8, v152
    s_nop 0
    s_cmp_lt_u32 s8, 1
    s_cbranch_scc1 SPIN_1
    s_setprio 1
    ds_read_b64_tr_b16 v[128:129], v112 offset:0
    ds_read_b64_tr_b16 v[130:131], v112 offset:6144
    ds_read_b128 v[64:67], v2 offset:0
    ds_read_b128 v[68:71], v2 offset:4096
    ds_read_b128 v[72:75], v2 offset:8192
    ds_read_b128 v[76:79], v2 offset:12288
    ds_read_b64_tr_b16 v[132:133], v113 offset:0
    ds_read_b64_tr_b16 v[134:135], v113 offset:6144
    ds_read_b64_tr_b16 v[136:137], v114 offset:0
    ds_read_b64_tr_b16 v[138:139], v114 offset:6144
SPIN_2:
    ds_read_b128 v[152:155], v8 offset:0
    s_waitcnt lgkmcnt(0)
    v_min3_u32 v152, v152, v153, v154
    v_min_u32 v152, v152, v155
    s_nop 0
    v_readfirstlane_b32 s8, v152
    s_nop 0
    s_cmp_lt_u32 s8, 2
    s_cbranch_scc1 SPIN_2
    v_mfma_f32_16x16x32_bf16 v[16:19], v[128:131], v[64:67], 0
    ds_write_b32 v7, v1 offset:48
    v_mfma_f32_16x16x32_bf16 v[20:23], v[128:131], v[68:71], 0
    ds_read_b64_tr_b16 v[140:141], v112 offset:12288
    v_mfma_f32_16x16x32_bf16 v[24:27], v[128:131], v[72:75], 0
    ds_read_b64_tr_b16 v[142:143], v112 offset:18432
    v_mov_b32 v1, 2
    v_mfma_f32_16x16x32_bf16 v[28:31], v[128:131], v[76:79], 0
    ds_read_b128 v[80:83], v3 offset:0
    v_mfma_f32_16x16x32_bf16 v[96:99], v[128:131], v[108:111], 0
    ds_read_b128 v[84:87], v3 offset:4096
    v_mfma_f32_16x16x32_bf16 v[32:35], v[132:135], v[64:67], 0
    ds_read_b128 v[88:91], v3 offset:8192
    v_mfma_f32_16x16x32_bf16 v[36:39], v[132:135], v[68:71], 0
    ds_read_b128 v[92:95], v3 offset:12288
    v_mfma_f32_16x16x32_bf16 v[40:43], v[132:135], v[72:75], 0
    ds_read_b128 v[152:155], v8 offset:0
    ds_read_b64_tr_b16 v[144:145], v113 offset:12288
    v_mfma_f32_16x16x32_bf16 v[44:47], v[132:135], v[76:79], 0
    ds_read_b64_tr_b16 v[146:147], v113 offset:18432
    v_mfma_f32_16x16x32_bf16 v[100:103], v[132:135], v[108:111], 0
    ds_read_b64_tr_b16 v[148:149], v114 offset:12288
    v_mfma_f32_16x16x32_bf16 v[48:51], v[136:139], v[64:67], 0
    ds_read_b64_tr_b16 v[150:151], v114 offset:18432
    v_mfma_f32_16x16x32_bf16 v[52:55], v[136:139], v[68:71], 0
    ds_write_b32 v7, v1 offset:48
    s_waitcnt lgkmcnt(5)
    v_min3_u32 v152, v152, v153, v154
    v_mfma_f32_16x16x32_bf16 v[56:59], v[136:139], v[72:75], 0
    v_min_u32 v152, v152, v155
    v_mfma_f32_16x16x32_bf16 v[60:63], v[136:139], v[76:79], 0
    v_readfirstlane_b32 s8, v152
    v_mfma_f32_16x16x32_bf16 v[104:107], v[136:139], v[108:111], 0
    s_cmp_lt_u32 s8, 3
    s_cbranch_scc1 GSLOW_3
GBACK_4:
    v_mfma_f32_16x16x32_bf16 v[16:19], v[140:143], v[80:83], v[16:19]
    ds_read_b64_tr_b16 v[128:129], v112 offset:24576
    v_mfma_f32_16x16x32_bf16 v[20:23], v[140:143], v[84:87], v[20:23]
    ds_read_b64_tr_b16 v[130:131], v112 offset:30720
    v_mfma_f32_16x16x32_bf16 v[24:27], v[140:143], v[88:91], v[24:27]
    ds_read_b128 v[64:67], v4 offset:0
    v_mov_b32 v1, 3
    v_mfma_f32_16x16x32_bf16 v[28:31], v[140:143], v[92:95], v[28:31]
    ds_read_b128 v[68:71], v4 offset:4096
    v_mfma_f32_16x16x32_bf16 v[96:99], v[140:143], v[108:111], v[96:99]
    ds_read_b128 v[72:75], v4 offset:8192
    s_waitcnt lgkmcnt(8)
    v_mfma_f32_16x16x32_bf16 v[32:35], v[144:147], v[80:83], v[32:35]
    ds_read_b128 v[76:79], v4 offset:12288
    v_mfma_f32_16x16x32_bf16 v[36:39], v[144:147], v[84:87], v[36:39]
    ds_read_b64_tr_b16 v[132:133], v113 offset:24576
    v_mfma_f32_16x16x32_bf16 v[40:43], v[144:147], v[88:91], v[40:43]
    ds_read_b128 v[152:155], v8 offset:0
    ds_read_b64_tr_b16 v[134:135], v113 offset:30720
    v_mfma_f32_16x16x32_bf16 v[44:47], v[144:147], v[92:95], v[44:47]
    ds_read_b64_tr_b16 v[136:137], v114 offset:24576
    v_mfma_f32_16x16x32_bf16 v[100:103], v[144:147], v[108:111], v[100:103]
    ds_read_b64_tr_b16 v[138:139], v114 offset:30720
    s_waitcnt lgkmcnt(12)
    v_mfma_f32_16x16x32_bf16 v[48:51], v[148:151], v[80:83], v[48:51]
    v_mfma_f32_16x16x32_bf16 v[52:55], v[148:151], v[84:87], v[52:55]
    ds_write_b32 v7, v1 offset:48
    s_waitcnt lgkmcnt(4)
    v_min3_u32 v152, v152, v153, v154
    v_mfma_f32_16x16x32_bf16 v[56:59], v[148:151], v[88:91], v[56:59]
    v_min_u32 v152, v152, v155
    v_mfma_f32_16x16x32_bf16 v[60:63], v[148:151], v[92:95], v[60:63]
    v_readfirstlane_b32 s8, v152
    v_mfma_f32_16x16x32_bf16 v[104:107], v[148:151], v[108:111], v[104:107]
    s_cmp_lt_u32 s8, 4
    s_cbranch_scc1 GSLOW_5
GBACK_6:
    s_waitcnt vmcnt(0)
    ds_write_b32 v7, v6 offset:240
    v_mfma_f32_16x16x32_bf16 v[16:19], v[128:131], v[64:67], v[16:19]
    ds_read_b64_tr_b16 v[140:141], v112 offset:36864
    v_mfma_f32_16x16x32_bf16 v[20:23], v[128:131], v[68:71], v[20:23]
    ds_read_b64_tr_b16 v[142:143], v112 offset:43008
    v_mfma_f32_16x16x32_bf16 v[24:27], v[128:131], v[72:75], v[24:27]
    ds_read_b128 v[80:83], v5 offset:0
    v_mov_b32 v1, 4
    v_mfma_f32_16x16x32_bf16 v[28:31], v[128:131], v[76:79], v[28:31]
    ds_read_b128 v[84:87], v5 offset:4096
    v_mfma_f32_16x16x32_bf16 v[96:99], v[128:131], v[108:111], v[96:99]
    ds_read_b128 v[88:91], v5 offset:8192
    s_waitcnt lgkmcnt(9)
    v_mfma_f32_16x16x32_bf16 v[32:35], v[132:135], v[64:67], v[32:35]
    ds_read_b128 v[92:95], v5 offset:12288
    v_mfma_f32_16x16x32_bf16 v[36:39], v[132:135], v[68:71], v[36:39]
    ds_read_b64_tr_b16 v[144:145], v113 offset:36864
    v_mfma_f32_16x16x32_bf16 v[40:43], v[132:135], v[72:75], v[40:43]
    ds_read_b128 v[152:155], v8 offset:0
    ds_read_b64_tr_b16 v[146:147], v113 offset:43008
    v_mfma_f32_16x16x32_bf16 v[44:47], v[132:135], v[76:79], v[44:47]
    ds_read_b64_tr_b16 v[148:149], v114 offset:36864
    v_mfma_f32_16x16x32_bf16 v[100:103], v[132:135], v[108:111], v[100:103]
    ds_read_b64_tr_b16 v[150:151], v114 offset:43008
    s_waitcnt lgkmcnt(13)
    v_mfma_f32_16x16x32_bf16 v[48:51], v[136:139], v[64:67], v[48:51]
    v_mfma_f32_16x16x32_bf16 v[52:55], v[136:139], v[68:71], v[52:55]
    ds_write_b32 v7, v1 offset:48
    s_waitcnt lgkmcnt(4)
    v_min3_u32 v152, v152, v153, v154
    v_mfma_f32_16x16x32_bf16 v[56:59], v[136:139], v[72:75], v[56:59]
    v_min_u32 v152, v152, v155
    v_mfma_f32_16x16x32_bf16 v[60:63], v[136:139], v[76:79], v[60:63]
    v_readfirstlane_b32 s8, v152
    v_mfma_f32_16x16x32_bf16 v[104:107], v[136:139], v[108:111], v[104:107]
    s_cmp_lt_u32 s8, 5
    s_cbranch_scc1 GSLOW_7
GBACK_8:
    v_mfma_f32_16x16x32_bf16 v[16:19], v[140:143], v[80:83], v[16:19]
    ds_read_b64_tr_b16 v[128:129], v115 offset:0
    v_mfma_f32_16x16x32_bf16 v[20:23], v[140:143], v[84:87], v[20:23]
    ds_read_b64_tr_b16 v[130:131], v115 offset:6144
    v_mfma_f32_16x16x32_bf16 v[24:27], v[140:143], v[88:91], v[24:27]
    ds_read_b128 v[64:67], v2 offset:16384
    v_mov_b32 v1, 5
    v_mfma_f32_16x16x32_bf16 v[28:31], v[140:143], v[92:95], v[28:31]
    ds_read_b128 v[68:71], v2 offset:20480
    v_mfma_f32_16x16x32_bf16 v[96:99], v[140:143], v[108:111], v[96:99]
    ds_read_b128 v[72:75], v2 offset:24576
    s_waitcnt lgkmcnt(8)
    v_mfma_f32_16x16x32_bf16 v[32:35], v[144:147], v[80:83], v[32:35]
    ds_read_b128 v[76:79], v2 offset:28672
    v_mfma_f32_16x16x32_bf16 v[36:39], v[144:147], v[84:87], v[36:39]
    ds_read_b64_tr_b16 v[132:133], v116 offset:0
    v_mfma_f32_16x16x32_bf16 v[40:43], v[144:147], v[88:91], v[40:43]
    ds_read_b128 v[152:155], v8 offset:0
    ds_read_b64_tr_b16 v[134:135], v116 offset:6144
    v_mfma_f32_16x16x32_bf16 v[44:47], v[144:147], v[92:95], v[44:47]
    ds_read_b64_tr_b16 v[136:137], v117 offset:0
    v_mfma_f32_16x16x32_bf16 v[100:103], v[144:147], v[108:111], v[100:103]
    ds_read_b64_tr_b16 v[138:139], v117 offset:6144
    s_waitcnt lgkmcnt(12)
    v_mfma_f32_16x16x32_bf16 v[48:51], v[148:151], v[80:83], v[48:51]
    v_mfma_f32_16x16x32_bf16 v[52:55], v[148:151], v[84:87], v[52:55]
    ds_write_b32 v7, v1 offset:48
    s_waitcnt lgkmcnt(4)
    v_min3_u32 v152, v152, v153, v154
    v_mfma_f32_16x16x32_bf16 v[56:59], v[148:151], v[88:91], v[56:59]
    v_min_u32 v152, v152, v155
    v_mfma_f32_16x16x32_bf16 v[60:63], v[148:151], v[92:95], v[60:63]
    v_readfirstlane_b32 s8, v152
    v_mfma_f32_16x16x32_bf16 v[104:107], v[148:151], v[108:111], v[104:107]
    s_cmp_lt_u32 s8, 6
    s_cbranch_scc1 GSLOW_9
GBACK_10:
    v_mfma_f32_16x16x32_bf16 v[16:19], v[128:131], v[64:67], v[16:19]
    ds_read_b64_tr_b16 v[140:141], v115 offset:12288
    v_mfma_f32_16x16x32_bf16 v[20:23], v[128:131], v[68:71], v[20:23]
    ds_read_b64_tr_b16 v[142:143], v115 offset:18432
    v_mfma_f32_16x16x32_bf16 v[24:27], v[128:131], v[72:75], v[24:27]
    ds_read_b128 v[80:83], v3 offset:16384
    v_mov_b32 v1, 6
    v_mfma_f32_16x16x32_bf16 v[28:31], v[128:131], v[76:79], v[28:31]
    ds_read_b128 v[84:87], v3 offset:20480
    v_mfma_f32_16x16x32_bf16 v[96:99], v[128:131], v[108:111], v[96:99]
    ds_read_b128 v[88:91], v3 offset:24576
    s_waitcnt lgkmcnt(8)
    v_mfma_f32_16x16x32_bf16 v[32:35], v[132:135], v[64:67], v[32:35]
    ds_read_b128 v[92:95], v3 offset:28672
    v_mfma_f32_16x16x32_bf16 v[36:39], v[132:135], v[68:71], v[36:39]
    ds_read_b64_tr_b16 v[144:145], v116 offset:12288
    v_mfma_f32_16x16x32_bf16 v[40:43], v[132:135], v[72:75], v[40:43]
    ds_read_b128 v[152:155], v8 offset:0
    ds_read_b64_tr_b16 v[146:147], v116 offset:18432
    v_mfma_f32_16x16x32_bf16 v[44:47], v[132:135], v[76:79], v[44:47]
    ds_read_b64_tr_b16 v[148:149], v117 offset:12288
    v_mfma_f32_16x16x32_bf16 v[100:103], v[132:135], v[108:111], v[100:103]
    ds_read_b64_tr_b16 v[150:151], v117 offset:18432
    s_waitcnt lgkmcnt(12)
    v_mfma_f32_16x16x32_bf16 v[48:51], v[136:139], v[64:67], v[48:51]
    v_mfma_f32_16x16x32_bf16 v[52:55], v[136:139], v[68:71], v[52:55]
    ds_write_b32 v7, v1 offset:48
    s_waitcnt lgkmcnt(4)
    v_min3_u32 v152, v152, v153, v154
    v_mfma_f32_16x16x32_bf16 v[56:59], v[136:139], v[72:75], v[56:59]
    v_min_u32 v152, v152, v155
    v_mfma_f32_16x16x32_bf16 v[60:63], v[136:139], v[76:79], v[60:63]
    v_readfirstlane_b32 s8, v152
    v_mfma_f32_16x16x32_bf16 v[104:107], v[136:139], v[108:111], v[104:107]
    s_cmp_lt_u32 s8, 7
    s_cbranch_scc1 GSLOW_11
GBACK_12:
    v_mfma_f32_16x16x32_bf16 v[16:19], v[140:143], v[80:83], v[16:19]
    ds_read_b64_tr_b16 v[128:129], v115 offset:24576
    v_mfma_f32_16x16x32_bf16 v[20:23], v[140:143], v[84:87], v[20:23]
    ds_read_b64_tr_b16 v[130:131], v115 offset:30720
    v_mfma_f32_16x16x32_bf16 v[24:27], v[140:143], v[88:91], v[24:27]
    ds_read_b128 v[64:67], v4 offset:16384
    v_mov_b32 v1, 7
    v_mfma_f32_16x16x32_bf16 v[28:31], v[140:143], v[92:95], v[28:31]
    ds_read_b128 v[68:71], v4 offset:20480
    v_mfma_f32_16x16x32_bf16 v[96:99], v[140:143], v[108:111], v[96:99]
    ds_read_b128 v[72:75], v4 offset:24576
    s_waitcnt lgkmcnt(8)
    v_mfma_f32_16x16x32_bf16 v[32:35], v[144:147], v[80:83], v[32:35]
    ds_read_b128 v[76:79], v4 offset:28672
    v_mfma_f32_16x16x32_bf16 v[36:39], v[144:147], v[84:87], v[36:39]
    ds_read_b64_tr_b16 v[132:133], v116 offset:24576
    v_mfma_f32_16x16x32_bf16 v[40:43], v[144:147], v[88:91], v[40:43]
    ds_read_b128 v[152:155], v8 offset:0
    ds_read_b64_tr_b16 v[134:135], v116 offset:30720
    v_mfma_f32_16x16x32_bf16 v[44:47], v[144:147], v[92:95], v[44:47]
    ds_read_b64_tr_b16 v[136:137], v117 offset:24576
    v_mfma_f32_16x16x32_bf16 v[100:103], v[144:147], v[108:111], v[100:103]
    ds_read_b64_tr_b16 v[138:139], v117 offset:30720
    s_waitcnt lgkmcnt(12)
    v_mfma_f32_16x16x32_bf16 v[48:51], v[148:151], v[80:83], v[48:51]
    v_mfma_f32_16x16x32_bf16 v[52:55], v[148:151], v[84:87], v[52:55]
    ds_write_b32 v7, v1 offset:48
    s_waitcnt lgkmcnt(4)
    v_min3_u32 v152, v152, v153, v154
    v_mfma_f32_16x16x32_bf16 v[56:59], v[148:151], v[88:91], v[56:59]
    v_min_u32 v152, v152, v155
    v_mfma_f32_16x16x32_bf16 v[60:63], v[148:151], v[92:95], v[60:63]
    v_readfirstlane_b32 s8, v152
    v_mfma_f32_16x16x32_bf16 v[104:107], v[148:151], v[108:111], v[104:107]
    s_cmp_lt_u32 s8, 8
    s_cbranch_scc1 GSLOW_13
GBACK_14:
    v_mfma_f32_16x16x32_bf16 v[16:19], v[128:131], v[64:67], v[16:19]
    ds_read_b64_tr_b16 v[140:141], v112 offset:0
    v_mfma_f32_16x16x32_bf16 v[20:23], v[128:131], v[68:71], v[20:23]
    ds_read_b64_tr_b16 v[142:143], v112 offset:6144
    v_mfma_f32_16x16x32_bf16 v[24:27], v[128:131], v[72:75], v[24:27]
    ds_read_b128 v[80:83], v5 offset:16384
    v_mov_b32 v1, 8
    v_mfma_f32_16x16x32_bf16 v[28:31], v[128:131], v[76:79], v[28:31]
    ds_read_b128 v[84:87], v5 offset:20480
    v_mfma_f32_16x16x32_bf16 v[96:99], v[128:131], v[108:111], v[96:99]
    ds_read_b128 v[88:91], v5 offset:24576
    s_waitcnt lgkmcnt(8)
    v_mfma_f32_16x16x32_bf16 v[32:35], v[132:135], v[64:67], v[32:35]
    ds_read_b128 v[92:95], v5 offset:28672
    v_mfma_f32_16x16x32_bf16 v[36:39], v[132:135], v[68:71], v[36:39]
    ds_read_b64_tr_b16 v[144:145], v113 offset:0
    v_mfma_f32_16x16x32_bf16 v[40:43], v[132:135], v[72:75], v[40:43]
    ds_read_b128 v[152:155], v8 offset:0
    ds_read_b64_tr_b16 v[146:147], v113 offset:6144
    v_mfma_f32_16x16x32_bf16 v[44:47], v[132:135], v[76:79], v[44:47]
    ds_read_b64_tr_b16 v[148:149], v114 offset:0
    v_mfma_f32_16x16x32_bf16 v[100:103], v[132:135], v[108:111], v[100:103]
    ds_read_b64_tr_b16 v[150:151], v114 offset:6144
    s_waitcnt lgkmcnt(12)
    v_mfma_f32_16x16x32_bf16 v[48:51], v[136:139], v[64:67], v[48:51]
    v_mfma_f32_16x16x32_bf16 v[52:55], v[136:139], v[68:71], v[52:55]
    ds_write_b32 v7, v1 offset:48
    s_waitcnt lgkmcnt(4)
    v_min3_u32 v152, v152, v153, v154
    v_mfma_f32_16x16x32_bf16 v[56:59], v[136:139], v[72:75], v[56:59]
    v_min_u32 v152, v152, v155
    v_mfma_f32_16x16x32_bf16 v[60:63], v[136:139], v[76:79], v[60:63]
    v_readfirstlane_b32 s8, v152
    v_mfma_f32_16x16x32_bf16 v[104:107], v[136:139], v[108:111], v[104:107]
    s_cmp_lt_u32 s8, 9
    s_cbranch_scc1 GSLOW_15
GBACK_16:
    v_mfma_f32_16x16x32_bf16 v[16:19], v[140:143], v[80:83], v[16:19]
    ds_read_b64_tr_b16 v[128:129], v112 offset:12288
    v_mfma_f32_16x16x32_bf16 v[20:23], v[140:143], v[84:87], v[20:23]
    ds_read_b64_tr_b16 v[130:131], v112 offset:18432
    v_mfma_f32_16x16x32_bf16 v[24:27], v[140:143], v[88:91], v[24:27]
    ds_read_b128 v[64:67], v2 offset:32768
    v_mov_b32 v1, 9
    v_mfma_f32_16x16x32_bf16 v[28:31], v[140:143], v[92:95], v[28:31]
    ds_read_b128 v[68:71], v2 offset:36864
    v_mfma_f32_16x16x32_bf16 v[96:99], v[140:143], v[108:111], v[96:99]
    ds_read_b128 v[72:75], v2 offset:40960
    s_waitcnt lgkmcnt(8)
    v_mfma_f32_16x16x32_bf16 v[32:35], v[144:147], v[80:83], v[32:35]
    ds_read_b128 v[76:79], v2 offset:45056
    v_mfma_f32_16x16x32_bf16 v[36:39], v[144:147], v[84:87], v[36:39]
    ds_read_b64_tr_b16 v[132:133], v113 offset:12288
    v_mfma_f32_16x16x32_bf16 v[40:43], v[144:147], v[88:91], v[40:43]
    ds_read_b128 v[152:155], v8 offset:0
    ds_read_b64_tr_b16 v[134:135], v113 offset:18432
    v_mfma_f32_16x16x32_bf16 v[44:47], v[144:147], v[92:95], v[44:47]
    ds_read_b64_tr_b16 v[136:137], v114 offset:12288
    v_mfma_f32_16x16x32_bf16 v[100:103], v[144:147], v[108:111], v[100:103]
    ds_read_b64_tr_b16 v[138:139], v114 offset:18432
    s_waitcnt lgkmcnt(12)
    v_mfma_f32_16x16x32_bf16 v[48:51], v[148:151], v[80:83], v[48:51]
    v_mfma_f32_16x16x32_bf16 v[52:55], v[148:151], v[84:87], v[52:55]
    ds_write_b32 v7, v1 offset:48
    s_waitcnt lgkmcnt(4)
    v_min3_u32 v152, v152, v153, v154
    v_mfma_f32_16x16x32_bf16 v[56:59], v[148:151], v[88:91], v[56:59]
    v_min_u32 v152, v152, v155
    v_mfma_f32_16x16x32_bf16 v[60:63], v[148:151], v[92:95], v[60:63]
    v_readfirstlane_b32 s8, v152
    v_mfma_f32_16x16x32_bf16 v[104:107], v[148:151], v[108:111], v[104:107]
    s_cmp_lt_u32 s8, 10
    s_cbranch_scc1 GSLOW_17
GBACK_18:
    v_mfma_f32_16x16x32_bf16 v[16:19], v[128:131], v[64:67], v[16:19]
    ds_read_b64_tr_b16 v[140:141], v112 offset:24576
    v_mfma_f32_16x16x32_bf16 v[20:23], v[128:131], v[68:71], v[20:23]
    ds_read_b64_tr_b16 v[142:143], v112 offset:30720
    v_mfma_f32_16x16x32_bf16 v[24:27], v[128:131], v[72:75], v[24:27]
    ds_read_b128 v[80:83], v3 offset:32768
    v_mov_b32 v1, 10
    v_mfma_f32_16x16x32_bf16 v[28:31], v[128:131], v[76:79], v[28:31]
    ds_read_b128 v[84:87], v3 offset:36864
    v_mfma_f32_16x16x32_bf16 v[96:99], v[128:131], v[108:111], v[96:99]
    ds_read_b128 v[88:91], v3 offset:40960
    s_waitcnt lgkmcnt(8)
    v_mfma_f32_16x16x32_bf16 v[32:35], v[132:135], v[64:67], v[32:35]
    ds_read_b128 v[92:95], v3 offset:45056
    v_mfma_f32_16x16x32_bf16 v[36:39], v[132:135], v[68:71], v[36:39]
    ds_read_b64_tr_b16 v[144:145], v113 offset:24576
    v_mfma_f32_16x16x32_bf16 v[40:43], v[132:135], v[72:75], v[40:43]
    ds_read_b128 v[152:155], v8 offset:0
    ds_read_b64_tr_b16 v[146:147], v113 offset:30720
    v_mfma_f32_16x16x32_bf16 v[44:47], v[132:135], v[76:79], v[44:47]
    ds_read_b64_tr_b16 v[148:149], v114 offset:24576
    v_mfma_f32_16x16x32_bf16 v[100:103], v[132:135], v[108:111], v[100:103]
    ds_read_b64_tr_b16 v[150:151], v114 offset:30720
    s_waitcnt lgkmcnt(12)
    v_mfma_f32_16x16x32_bf16 v[48:51], v[136:139], v[64:67], v[48:51]
    v_mfma_f32_16x16x32_bf16 v[52:55], v[136:139], v[68:71], v[52:55]
    s_waitcnt lgkmcnt(3)
    v_min3_u32 v152, v152, v153, v154
    v_mfma_f32_16x16x32_bf16 v[56:59], v[136:139], v[72:75], v[56:59]
    v_min_u32 v152, v152, v155
    v_mfma_f32_16x16x32_bf16 v[60:63], v[136:139], v[76:79], v[60:63]
    v_readfirstlane_b32 s8, v152
    v_mfma_f32_16x16x32_bf16 v[104:107], v[136:139], v[108:111], v[104:107]
    s_cmp_lt_u32 s8, 11
    s_cbranch_scc1 GSLOW_19
GBACK_20:
    v_mfma_f32_16x16x32_bf16 v[16:19], v[140:143], v[80:83], v[16:19]
    ds_read_b64_tr_b16 v[128:129], v112 offset:36864
    v_mfma_f32_16x16x32_bf16 v[20:23], v[140:143], v[84:87], v[20:23]
    ds_read_b64_tr_b16 v[130:131], v112 offset:43008
    v_mfma_f32_16x16x32_bf16 v[24:27], v[140:143], v[88:91], v[24:27]
    ds_read_b128 v[64:67], v4 offset:32768
    v_mov_b32 v1, 11
    v_mfma_f32_16x16x32_bf16 v[28:31], v[140:143], v[92:95], v[28:31]
    ds_read_b128 v[68:71], v4 offset:36864
    v_mfma_f32_16x16x32_bf16 v[96:99], v[140:143], v[108:111], v[96:99]
    ds_read_b128 v[72:75], v4 offset:40960
    s_waitcnt lgkmcnt(7)
    v_mfma_f32_16x16x32_bf16 v[32:35], v[144:147], v[80:83], v[32:35]
    ds_read_b128 v[76:79], v4 offset:45056
    v_mfma_f32_16x16x32_bf16 v[36:39], v[144:147], v[84:87], v[36:39]
    ds_read_b64_tr_b16 v[132:133], v113 offset:36864
    v_mfma_f32_16x16x32_bf16 v[40:43], v[144:147], v[88:91], v[40:43]
    ds_read_b128 v[152:155], v8 offset:0
    ds_read_b64_tr_b16 v[134:135], v113 offset:43008
    v_mfma_f32_16x16x32_bf16 v[44:47], v[144:147], v[92:95], v[44:47]
    ds_read_b64_tr_b16 v[136:137], v114 offset:36864
    v_mfma_f32_16x16x32_bf16 v[100:103], v[144:147], v[108:111], v[100:103]
    ds_read_b64_tr_b16 v[138:139], v114 offset:43008
    s_waitcnt lgkmcnt(11)
    v_mfma_f32_16x16x32_bf16 v[48:51], v[148:151], v[80:83], v[48:51]
    v_mfma_f32_16x16x32_bf16 v[52:55], v[148:151], v[84:87], v[52:55]
    s_waitcnt lgkmcnt(3)
    v_min3_u32 v152, v152, v153, v154
    v_mfma_f32_16x16x32_bf16 v[56:59], v[148:151], v[88:91], v[56:59]
    v_min_u32 v152, v152, v155
    v_mfma_f32_16x16x32_bf16 v[60:63], v[148:151], v[92:95], v[60:63]
    v_readfirstlane_b32 s8, v152
    v_mfma_f32_16x16x32_bf16 v[104:107], v[148:151], v[108:111], v[104:107]
    s_cmp_lt_u32 s8, 12
    s_cbranch_scc1 GSLOW_21
GBACK_22:
    v_mfma_f32_16x16x32_bf16 v[16:19], v[128:131], v[64:67], v[16:19]
    ds_read_b64_tr_b16 v[140:141], v115 offset:0
    v_mfma_f32_16x16x32_bf16 v[20:23], v[128:131], v[68:71], v[20:23]
    ds_read_b64_tr_b16 v[142:143], v115 offset:6144
    v_mfma_f32_16x16x32_bf16 v[24:27], v[128:131], v[72:75], v[24:27]
    ds_read_b128 v[80:83], v5 offset:32768
    v_mov_b32 v1, 12
    v_mfma_f32_16x16x32_bf16 v[28:31], v[128:131], v[76:79], v[28:31]
    ds_read_b128 v[84:87], v5 offset:36864
    v_mfma_f32_16x16x32_bf16 v[96:99], v[128:131], v[108:111], v[96:99]
    ds_read_b128 v[88:91], v5 offset:40960
    s_waitcnt lgkmcnt(7)
    v_mfma_f32_16x16x32_bf16 v[32:35], v[132:135], v[64:67], v[32:35]
    ds_read_b128 v[92:95], v5 offset:45056
    v_mfma_f32_16x16x32_bf16 v[36:39], v[132:135], v[68:71], v[36:39]
    ds_read_b64_tr_b16 v[144:145], v116 offset:0
    v_mfma_f32_16x16x32_bf16 v[40:43], v[132:135], v[72:75], v[40:43]
    ds_read_b128 v[152:155], v8 offset:0
    ds_read_b64_tr_b16 v[146:147], v116 offset:6144
    v_mfma_f32_16x16x32_bf16 v[44:47], v[132:135], v[76:79], v[44:47]
    ds_read_b64_tr_b16 v[148:149], v117 offset:0
    v_mfma_f32_16x16x32_bf16 v[100:103], v[132:135], v[108:111], v[100:103]
    ds_read_b64_tr_b16 v[150:151], v117 offset:6144
    s_waitcnt lgkmcnt(11)
    v_mfma_f32_16x16x32_bf16 v[48:51], v[136:139], v[64:67], v[48:51]
    v_mfma_f32_16x16x32_bf16 v[52:55], v[136:139], v[68:71], v[52:55]
    ds_write_b32 v7, v1 offset:48
    s_waitcnt lgkmcnt(4)
    v_min3_u32 v152, v152, v153, v154
    v_mfma_f32_16x16x32_bf16 v[56:59], v[136:139], v[72:75], v[56:59]
    v_min_u32 v152, v152, v155
    v_mfma_f32_16x16x32_bf16 v[60:63], v[136:139], v[76:79], v[60:63]
    v_readfirstlane_b32 s8, v152
    v_mfma_f32_16x16x32_bf16 v[104:107], v[136:139], v[108:111], v[104:107]
    s_cmp_lt_u32 s8, 13
    s_cbranch_scc1 GSLOW_23
GBACK_24:
    v_mfma_f32_16x16x32_bf16 v[16:19], v[140:143], v[80:83], v[16:19]
    ds_read_b64_tr_b16 v[128:129], v115 offset:12288
    v_mfma_f32_16x16x32_bf16 v[20:23], v[140:143], v[84:87], v[20:23]
    ds_read_b64_tr_b16 v[130:131], v115 offset:18432
    v_mfma_f32_16x16x32_bf16 v[24:27], v[140:143], v[88:91], v[24:27]
    ds_read_b128 v[64:67], v2 offset:49152
    v_mov_b32 v1, 13
    v_mfma_f32_16x16x32_bf16 v[28:31], v[140:143], v[92:95], v[28:31]
    ds_read_b128 v[68:71], v2 offset:53248
    v_mfma_f32_16x16x32_bf16 v[96:99], v[140:143], v[108:111], v[96:99]
    ds_read_b128 v[72:75], v2 offset:57344
    s_waitcnt lgkmcnt(8)
    v_mfma_f32_16x16x32_bf16 v[32:35], v[144:147], v[80:83], v[32:35]
    ds_read_b128 v[76:79], v2 offset:61440
    v_mfma_f32_16x16x32_bf16 v[36:39], v[144:147], v[84:87], v[36:39]
    ds_read_b64_tr_b16 v[132:133], v116 offset:12288
    v_mfma_f32_16x16x32_bf16 v[40:43], v[144:147], v[88:91], v[40:43]
    ds_read_b128 v[152:155], v8 offset:0
    ds_read_b64_tr_b16 v[134:135], v116 offset:18432
    v_mfma_f32_16x16x32_bf16 v[44:47], v[144:147], v[92:95], v[44:47]
    ds_read_b64_tr_b16 v[136:137], v117 offset:12288
    v_mfma_f32_16x16x32_bf16 v[100:103], v[144:147], v[108:111], v[100:103]
    ds_read_b64_tr_b16 v[138:139], v117 offset:18432
    s_waitcnt lgkmcnt(12)
    v_mfma_f32_16x16x32_bf16 v[48:51], v[148:151], v[80:83], v[48:51]
    v_mfma_f32_16x16x32_bf16 v[52:55], v[148:151], v[84:87], v[52:55]
    s_waitcnt lgkmcnt(3)
    v_min3_u32 v152, v152, v153, v154
    v_mfma_f32_16x16x32_bf16 v[56:59], v[148:151], v[88:91], v[56:59]
    v_min_u32 v152, v152, v155
    v_mfma_f32_16x16x32_bf16 v[60:63], v[148:151], v[92:95], v[60:63]
    v_readfirstlane_b32 s8, v152
    v_mfma_f32_16x16x32_bf16 v[104:107], v[148:151], v[108:111], v[104:107]
    s_cmp_lt_u32 s8, 14
    s_cbranch_scc1 GSLOW_25
GBACK_26:
    v_mfma_f32_16x16x32_bf16 v[16:19], v[128:131], v[64:67], v[16:19]
    ds_read_b64_tr_b16 v[140:141], v115 offset:24576
    v_mfma_f32_16x16x32_bf16 v[20:23], v[128:131], v[68:71], v[20:23]
    ds_read_b64_tr_b16 v[142:143], v115 offset:30720
    v_mfma_f32_16x16x32_bf16 v[24:27], v[128:131], v[72:75], v[24:27]
    ds_read_b128 v[80:83], v3 offset:49152
    v_mov_b32 v1, 14
    v_mfma_f32_16x16x32_bf16 v[28:31], v[128:131], v[76:79], v[28:31]
    ds_read_b128 v[84:87], v3 offset:53248
    v_mfma_f32_16x16x32_bf16 v[96:99], v[128:131], v[108:111], v[96:99]
    ds_read_b128 v[88:91], v3 offset:57344
    s_waitcnt lgkmcnt(7)
    v_mfma_f32_16x16x32_bf16 v[32:35], v[132:135], v[64:67], v[32:35]
    ds_read_b128 v[92:95], v3 offset:61440
    v_mfma_f32_16x16x32_bf16 v[36:39], v[132:135], v[68:71], v[36:39]
    ds_read_b64_tr_b16 v[144:145], v116 offset:24576
    v_mfma_f32_16x16x32_bf16 v[40:43], v[132:135], v[72:75], v[40:43]
    ds_read_b128 v[152:155], v8 offset:0
    ds_read_b64_tr_b16 v[146:147], v116 offset:30720
    v_mfma_f32_16x16x32_bf16 v[44:47], v[132:135], v[76:79], v[44:47]
    ds_read_b64_tr_b16 v[148:149], v117 offset:24576
    v_mfma_f32_16x16x32_bf16 v[100:103], v[132:135], v[108:111], v[100:103]
    ds_read_b64_tr_b16 v[150:151], v117 offset:30720
    s_waitcnt lgkmcnt(11)
    v_mfma_f32_16x16x32_bf16 v[48:51], v[136:139], v[64:67], v[48:51]
    v_mfma_f32_16x16x32_bf16 v[52:55], v[136:139], v[68:71], v[52:55]
    s_waitcnt lgkmcnt(3)
    v_min3_u32 v152, v152, v153, v154
    v_mfma_f32_16x16x32_bf16 v[56:59], v[136:139], v[72:75], v[56:59]
    v_min_u32 v152, v152, v155
    v_mfma_f32_16x16x32_bf16 v[60:63], v[136:139], v[76:79], v[60:63]
    v_readfirstlane_b32 s8, v152
    v_mfma_f32_16x16x32_bf16 v[104:107], v[136:139], v[108:111], v[104:107]
    s_cmp_lt_u32 s8, 15
    s_cbranch_scc1 GSLOW_27
GBACK_28:
    v_mfma_f32_16x16x32_bf16 v[16:19], v[140:143], v[80:83], v[16:19]
    ds_read_b64_tr_b16 v[128:129], v112 offset:0
    v_mfma_f32_16x16x32_bf16 v[20:23], v[140:143], v[84:87], v[20:23]
    ds_read_b64_tr_b16 v[130:131], v112 offset:6144
    v_mfma_f32_16x16x32_bf16 v[24:27], v[140:143], v[88:91], v[24:27]
    ds_read_b128 v[64:67], v4 offset:49152
    v_mov_b32 v1, 15
    v_mfma_f32_16x16x32_bf16 v[28:31], v[140:143], v[92:95], v[28:31]
    ds_read_b128 v[68:71], v4 offset:53248
    v_mfma_f32_16x16x32_bf16 v[96:99], v[140:143], v[108:111], v[96:99]
    ds_read_b128 v[72:75], v4 offset:57344
    s_waitcnt lgkmcnt(7)
    v_mfma_f32_16x16x32_bf16 v[32:35], v[144:147], v[80:83], v[32:35]
    ds_read_b128 v[76:79], v4 offset:61440
    v_mfma_f32_16x16x32_bf16 v[36:39], v[144:147], v[84:87], v[36:39]
    ds_read_b64_tr_b16 v[132:133], v113 offset:0
    v_mfma_f32_16x16x32_bf16 v[40:43], v[144:147], v[88:91], v[40:43]
    ds_read_b128 v[152:155], v8 offset:0
    ds_read_b64_tr_b16 v[134:135], v113 offset:6144
    v_mfma_f32_16x16x32_bf16 v[44:47], v[144:147], v[92:95], v[44:47]
    ds_read_b64_tr_b16 v[136:137], v114 offset:0
    v_mfma_f32_16x16x32_bf16 v[100:103], v[144:147], v[108:111], v[100:103]
    ds_read_b64_tr_b16 v[138:139], v114 offset:6144
    s_waitcnt lgkmcnt(11)
    v_mfma_f32_16x16x32_bf16 v[48:51], v[148:151], v[80:83], v[48:51]
    v_mfma_f32_16x16x32_bf16 v[52:55], v[148:151], v[84:87], v[52:55]
    s_waitcnt lgkmcnt(3)
    v_min3_u32 v152, v152, v153, v154
    v_mfma_f32_16x16x32_bf16 v[56:59], v[148:151], v[88:91], v[56:59]
    v_min_u32 v152, v152, v155
    v_mfma_f32_16x16x32_bf16 v[60:63], v[148:151], v[92:95], v[60:63]
    v_readfirstlane_b32 s8, v152
    v_mfma_f32_16x16x32_bf16 v[104:107], v[148:151], v[108:111], v[104:107]
    s_cmp_lt_u32 s8, 16
    s_cbranch_scc1 GSLOW_29
GBACK_30:
    v_mfma_f32_16x16x32_bf16 v[16:19], v[128:131], v[64:67], v[16:19]
    ds_read_b64_tr_b16 v[140:141], v112 offset:12288
    v_mfma_f32_16x16x32_bf16 v[20:23], v[128:131], v[68:71], v[20:23]
    ds_read_b64_tr_b16 v[142:143], v112 offset:18432
    v_mfma_f32_16x16x32_bf16 v[24:27], v[128:131], v[72:75], v[24:27]
    ds_read_b128 v[80:83], v5 offset:49152
    v_mov_b32 v1, 16
    v_mfma_f32_16x16x32_bf16 v[28:31], v[128:131], v[76:79], v[28:31]
    ds_read_b128 v[84:87], v5 offset:53248
    v_mfma_f32_16x16x32_bf16 v[96:99], v[128:131], v[108:111], v[96:99]
    ds_read_b128 v[88:91], v5 offset:57344
    s_waitcnt lgkmcnt(7)
    v_mfma_f32_16x16x32_bf16 v[32:35], v[132:135], v[64:67], v[32:35]
    ds_read_b128 v[92:95], v5 offset:61440
    v_mfma_f32_16x16x32_bf16 v[36:39], v[132:135], v[68:71], v[36:39]
    ds_read_b64_tr_b16 v[144:145], v113 offset:12288
    v_mfma_f32_16x16x32_bf16 v[40:43], v[132:135], v[72:75], v[40:43]
    ds_read_b64_tr_b16 v[146:147], v113 offset:18432
    v_mfma_f32_16x16x32_bf16 v[44:47], v[132:135], v[76:79], v[44:47]
    ds_read_b64_tr_b16 v[148:149], v114 offset:12288
    v_mfma_f32_16x16x32_bf16 v[100:103], v[132:135], v[108:111], v[100:103]
    ds_read_b64_tr_b16 v[150:151], v114 offset:18432
    s_waitcnt lgkmcnt(10)
    v_mfma_f32_16x16x32_bf16 v[48:51], v[136:139], v[64:67], v[48:51]
    v_mfma_f32_16x16x32_bf16 v[52:55], v[136:139], v[68:71], v[52:55]
    ds_write_b32 v7, v1 offset:48
    v_mfma_f32_16x16x32_bf16 v[56:59], v[136:139], v[72:75], v[56:59]
    v_mfma_f32_16x16x32_bf16 v[60:63], v[136:139], v[76:79], v[60:63]
    v_mfma_f32_16x16x32_bf16 v[104:107], v[136:139], v[108:111], v[104:107]
    s_waitcnt lgkmcnt(8)
    v_mfma_f32_16x16x32_bf16 v[16:19], v[140:143], v[80:83], v[16:19]
    s_waitcnt lgkmcnt(7)
    v_mfma_f32_16x16x32_bf16 v[20:23], v[140:143], v[84:87], v[20:23]
    s_waitcnt lgkmcnt(6)
    v_mfma_f32_16x16x32_bf16 v[24:27], v[140:143], v[88:91], v[24:27]
    v_mov_b32 v1, 17
    s_waitcnt lgkmcnt(5)
    v_mfma_f32_16x16x32_bf16 v[28:31], v[140:143], v[92:95], v[28:31]
    v_mfma_f32_16x16x32_bf16 v[96:99], v[140:143], v[108:111], v[96:99]
    s_waitcnt lgkmcnt(3)
    v_mfma_f32_16x16x32_bf16 v[32:35], v[144:147], v[80:83], v[32:35]
    v_mfma_f32_16x16x32_bf16 v[36:39], v[144:147], v[84:87], v[36:39]
    v_mfma_f32_16x16x32_bf16 v[40:43], v[144:147], v[88:91], v[40:43]
    v_mfma_f32_16x16x32_bf16 v[44:47], v[144:147], v[92:95], v[44:47]
    v_mfma_f32_16x16x32_bf16 v[100:103], v[144:147], v[108:111], v[100:103]
    s_waitcnt lgkmcnt(1)
    v_mfma_f32_16x16x32_bf16 v[48:51], v[148:151], v[80:83], v[48:51]
    v_mfma_f32_16x16x32_bf16 v[52:55], v[148:151], v[84:87], v[52:55]
    v_mfma_f32_16x16x32_bf16 v[56:59], v[148:151], v[88:91], v[56:59]
    v_mfma_f32_16x16x32_bf16 v[60:63], v[148:151], v[92:95], v[60:63]
    v_mfma_f32_16x16x32_bf16 v[104:107], v[148:151], v[108:111], v[104:107]
SPIN_31:
    ds_read_b128 v[12:15], v8 offset:16
    s_waitcnt lgkmcnt(0)
    v_min3_u32 v12, v12, v13, v14
    v_min_u32 v12, v12, v15
    s_nop 0
    v_readfirstlane_b32 s8, v12
    s_nop 0
    s_cmp_lt_u32 s8, 1
    s_cbranch_scc1 SPIN_31
    v_lshlrev_b32 v12, 3, v9
    v_add_u32 v12, 159744, v12
    ds_read_b64 v[140:141], v12 offset:0
    ds_read_b64 v[142:143], v12 offset:128
    ds_read_b64 v[144:145], v12 offset:256
    ds_read_b64 v[146:147], v12 offset:384
    v_lshlrev_b32 v128, 16, v118
    v_and_b32 v129, 0xffff0000, v118
    v_lshlrev_b32 v130, 16, v119
    v_and_b32 v131, 0xffff0000, v119
    v_lshlrev_b32 v132, 16, v120
    v_and_b32 v133, 0xffff0000, v120
    v_lshlrev_b32 v134, 16, v121
    v_and_b32 v135, 0xffff0000, v121
    v_lshlrev_b32 v136, 16, v122
    v_and_b32 v137, 0xffff0000, v122
    v_lshlrev_b32 v138, 16, v123
    v_and_b32 v139, 0xffff0000, v123
    s_mul_i32 s8, s4, 172
    s_lshl_b32 s9, s6, 1
    s_add_u32 s8, s8, s9
    s_mul_i32 s9, s12, 3
    s_add_u32 s8, s8, s9
    s_lshl_b32 s8, s8, 10
    s_add_u32 s8, s8, 0
    s_add_u32 s9, s8, 88064
    s_lshr_b32 s10, 213, s5
    s_cmp_eq_u32 s12, 3
    s_cselect_b32 s10, s10, 0
    s_and_b32 s10, s10, 1
    s_setprio 3
    s_waitcnt lgkmcnt(0)
    v_pk_fma_f32 v[80:81], v[96:97], v[140:141], v[128:129] op_sel:[0,1,0] op_sel_hi:[1,1,1]
    v_pk_fma_f32 v[82:83], v[98:99], v[140:141], v[130:131] op_sel:[0,1,0] op_sel_hi:[1,1,1]
    v_pk_fma_f32 v[84:85], v[96:97], v[142:143], v[128:129] op_sel:[0,1,0] op_sel_hi:[1,1,1]
    v_pk_fma_f32 v[86:87], v[98:99], v[142:143], v[130:131] op_sel:[0,1,0] op_sel_hi:[1,1,1]
    v_pk_fma_f32 v[80:81], v[16:17], v[140:141], v[80:81] op_sel:[0,0,0] op_sel_hi:[1,0,1]
    v_pk_fma_f32 v[82:83], v[18:19], v[140:141], v[82:83] op_sel:[0,0,0] op_sel_hi:[1,0,1]
    v_pk_fma_f32 v[84:85], v[20:21], v[142:143], v[84:85] op_sel:[0,0,0] op_sel_hi:[1,0,1]
    v_pk_fma_f32 v[86:87], v[22:23], v[142:143], v[86:87] op_sel:[0,0,0] op_sel_hi:[1,0,1]
    v_mul_f32 v16, v80, |v80|
    v_mul_f32 v17, v81, |v81|
    v_mul_f32 v18, v82, |v82|
    v_mul_f32 v19, v83, |v83|
    v_mul_f32 v20, v84, |v84|
    v_mul_f32 v21, v85, |v85|
    v_mul_f32 v22, v86, |v86|
    v_mul_f32 v23, v87, |v87|
    v_cvt_pk_bf16_f32 v64, v16, v17
    v_cvt_pk_bf16_f32 v65, v18, v19
    v_cvt_pk_bf16_f32 v66, v20, v21
    v_cvt_pk_bf16_f32 v67, v22, v23
    v_pk_max_i16 v64, v64, 0
    v_pk_max_i16 v65, v65, 0
    v_pk_max_i16 v66, v66, 0
    v_pk_max_i16 v67, v67, 0
    s_nop 0
    v_permlane16_swap_b32 v64, v66
    v_permlane16_swap_b32 v65, v67
    buffer_store_dwordx4 v[64:67], v11, s[56:59], s8 offen offset:0 sc1
    v_pk_fma_f32 v[80:81], v[96:97], v[144:145], v[128:129] op_sel:[0,1,0] op_sel_hi:[1,1,1]
    v_pk_fma_f32 v[82:83], v[98:99], v[144:145], v[130:131] op_sel:[0,1,0] op_sel_hi:[1,1,1]
    v_pk_fma_f32 v[84:85], v[96:97], v[146:147], v[128:129] op_sel:[0,1,0] op_sel_hi:[1,1,1]
    v_pk_fma_f32 v[86:87], v[98:99], v[146:147], v[130:131] op_sel:[0,1,0] op_sel_hi:[1,1,1]
    v_pk_fma_f32 v[80:81], v[24:25], v[144:145], v[80:81] op_sel:[0,0,0] op_sel_hi:[1,0,1]
    v_pk_fma_f32 v[82:83], v[26:27], v[144:145], v[82:83] op_sel:[0,0,0] op_sel_hi:[1,0,1]
    v_pk_fma_f32 v[84:85], v[28:29], v[146:147], v[84:85] op_sel:[0,0,0] op_sel_hi:[1,0,1]
    v_pk_fma_f32 v[86:87], v[30:31], v[146:147], v[86:87] op_sel:[0,0,0] op_sel_hi:[1,0,1]
    v_mul_f32 v24, v80, |v80|
    v_mul_f32 v25, v81, |v81|
    v_mul_f32 v26, v82, |v82|
    v_mul_f32 v27, v83, |v83|
    v_mul_f32 v28, v84, |v84|
    v_mul_f32 v29, v85, |v85|
    v_mul_f32 v30, v86, |v86|
    v_mul_f32 v31, v87, |v87|
    v_cvt_pk_bf16_f32 v68, v24, v25
    v_cvt_pk_bf16_f32 v69, v26, v27
    v_cvt_pk_bf16_f32 v70, v28, v29
    v_cvt_pk_bf16_f32 v71, v30, v31
    v_pk_max_i16 v68, v68, 0
    v_pk_max_i16 v69, v69, 0
    v_pk_max_i16 v70, v70, 0
    v_pk_max_i16 v71, v71, 0
    s_nop 0
    v_permlane16_swap_b32 v68, v70
    v_permlane16_swap_b32 v69, v71
    buffer_store_dwordx4 v[68:71], v11, s[56:59], s9 offen offset:0 sc1
    s_cmp_eq_u32 s10, 1
    s_cbranch_scc1 KF_GEPI
    v_pk_fma_f32 v[80:81], v[100:101], v[140:141], v[132:133] op_sel:[0,1,0] op_sel_hi:[1,1,1]
    v_pk_fma_f32 v[82:83], v[102:103], v[140:141], v[134:135] op_sel:[0,1,0] op_sel_hi:[1,1,1]
    v_pk_fma_f32 v[84:85], v[100:101], v[142:143], v[132:133] op_sel:[0,1,0] op_sel_hi:[1,1,1]
    v_pk_fma_f32 v[86:87], v[102:103], v[142:143], v[134:135] op_sel:[0,1,0] op_sel_hi:[1,1,1]
    v_pk_fma_f32 v[80:81], v[32:33], v[140:141], v[80:81] op_sel:[0,0,0] op_sel_hi:[1,0,1]
    v_pk_fma_f32 v[82:83], v[34:35], v[140:141], v[82:83] op_sel:[0,0,0] op_sel_hi:[1,0,1]
    v_pk_fma_f32 v[84:85], v[36:37], v[142:143], v[84:85] op_sel:[0,0,0] op_sel_hi:[1,0,1]
    v_pk_fma_f32 v[86:87], v[38:39], v[142:143], v[86:87] op_sel:[0,0,0] op_sel_hi:[1,0,1]
    v_mul_f32 v32, v80, |v80|
    v_mul_f32 v33, v81, |v81|
    v_mul_f32 v34, v82, |v82|
    v_mul_f32 v35, v83, |v83|
    v_mul_f32 v36, v84, |v84|
    v_mul_f32 v37, v85, |v85|
    v_mul_f32 v38, v86, |v86|
    v_mul_f32 v39, v87, |v87|
    v_cvt_pk_bf16_f32 v72, v32, v33
    v_cvt_pk_bf16_f32 v73, v34, v35
    v_cvt_pk_bf16_f32 v74, v36, v37
    v_cvt_pk_bf16_f32 v75, v38, v39
    v_pk_max_i16 v72, v72, 0
    v_pk_max_i16 v73, v73, 0
    v_pk_max_i16 v74, v74, 0
    v_pk_max_i16 v75, v75, 0
    s_nop 0
    v_permlane16_swap_b32 v72, v74
    v_permlane16_swap_b32 v73, v75
    buffer_store_dwordx4 v[72:75], v11, s[56:59], s8 offen offset:1024 sc1
    v_pk_fma_f32 v[80:81], v[100:101], v[144:145], v[132:133] op_sel:[0,1,0] op_sel_hi:[1,1,1]
    v_pk_fma_f32 v[82:83], v[102:103], v[144:145], v[134:135] op_sel:[0,1,0] op_sel_hi:[1,1,1]
    v_pk_fma_f32 v[84:85], v[100:101], v[146:147], v[132:133] op_sel:[0,1,0] op_sel_hi:[1,1,1]
    v_pk_fma_f32 v[86:87], v[102:103], v[146:147], v[134:135] op_sel:[0,1,0] op_sel_hi:[1,1,1]
    v_pk_fma_f32 v[80:81], v[40:41], v[144:145], v[80:81] op_sel:[0,0,0] op_sel_hi:[1,0,1]
    v_pk_fma_f32 v[82:83], v[42:43], v[144:145], v[82:83] op_sel:[0,0,0] op_sel_hi:[1,0,1]
    v_pk_fma_f32 v[84:85], v[44:45], v[146:147], v[84:85] op_sel:[0,0,0] op_sel_hi:[1,0,1]
    v_pk_fma_f32 v[86:87], v[46:47], v[146:147], v[86:87] op_sel:[0,0,0] op_sel_hi:[1,0,1]
    v_mul_f32 v40, v80, |v80|
    v_mul_f32 v41, v81, |v81|
    v_mul_f32 v42, v82, |v82|
    v_mul_f32 v43, v83, |v83|
    v_mul_f32 v44, v84, |v84|
    v_mul_f32 v45, v85, |v85|
    v_mul_f32 v46, v86, |v86|
    v_mul_f32 v47, v87, |v87|
    v_cvt_pk_bf16_f32 v76, v40, v41
    v_cvt_pk_bf16_f32 v77, v42, v43
    v_cvt_pk_bf16_f32 v78, v44, v45
    v_cvt_pk_bf16_f32 v79, v46, v47
    v_pk_max_i16 v76, v76, 0
    v_pk_max_i16 v77, v77, 0
    v_pk_max_i16 v78, v78, 0
    v_pk_max_i16 v79, v79, 0
    s_nop 0
    v_permlane16_swap_b32 v76, v78
    v_permlane16_swap_b32 v77, v79
    buffer_store_dwordx4 v[76:79], v11, s[56:59], s9 offen offset:1024 sc1
    v_pk_fma_f32 v[80:81], v[104:105], v[140:141], v[136:137] op_sel:[0,1,0] op_sel_hi:[1,1,1]
    v_pk_fma_f32 v[82:83], v[106:107], v[140:141], v[138:139] op_sel:[0,1,0] op_sel_hi:[1,1,1]
    v_pk_fma_f32 v[84:85], v[104:105], v[142:143], v[136:137] op_sel:[0,1,0] op_sel_hi:[1,1,1]
    v_pk_fma_f32 v[86:87], v[106:107], v[142:143], v[138:139] op_sel:[0,1,0] op_sel_hi:[1,1,1]
    v_pk_fma_f32 v[80:81], v[48:49], v[140:141], v[80:81] op_sel:[0,0,0] op_sel_hi:[1,0,1]
    v_pk_fma_f32 v[82:83], v[50:51], v[140:141], v[82:83] op_sel:[0,0,0] op_sel_hi:[1,0,1]
    v_pk_fma_f32 v[84:85], v[52:53], v[142:143], v[84:85] op_sel:[0,0,0] op_sel_hi:[1,0,1]
    v_pk_fma_f32 v[86:87], v[54:55], v[142:143], v[86:87] op_sel:[0,0,0] op_sel_hi:[1,0,1]
    v_mul_f32 v48, v80, |v80|
    v_mul_f32 v49, v81, |v81|
    v_mul_f32 v50, v82, |v82|
    v_mul_f32 v51, v83, |v83|
    v_mul_f32 v52, v84, |v84|
    v_mul_f32 v53, v85, |v85|
    v_mul_f32 v54, v86, |v86|
    v_mul_f32 v55, v87, |v87|
    v_cvt_pk_bf16_f32 v64, v48, v49
    v_cvt_pk_bf16_f32 v65, v50, v51
    v_cvt_pk_bf16_f32 v66, v52, v53
    v_cvt_pk_bf16_f32 v67, v54, v55
    v_pk_max_i16 v64, v64, 0
    v_pk_max_i16 v65, v65, 0
    v_pk_max_i16 v66, v66, 0
    v_pk_max_i16 v67, v67, 0
    s_nop 0
    v_permlane16_swap_b32 v64, v66
    v_permlane16_swap_b32 v65, v67
    buffer_store_dwordx4 v[64:67], v11, s[56:59], s8 offen offset:2048 sc1
    v_pk_fma_f32 v[80:81], v[104:105], v[144:145], v[136:137] op_sel:[0,1,0] op_sel_hi:[1,1,1]
    v_pk_fma_f32 v[82:83], v[106:107], v[144:145], v[138:139] op_sel:[0,1,0] op_sel_hi:[1,1,1]
    v_pk_fma_f32 v[84:85], v[104:105], v[146:147], v[136:137] op_sel:[0,1,0] op_sel_hi:[1,1,1]
    v_pk_fma_f32 v[86:87], v[106:107], v[146:147], v[138:139] op_sel:[0,1,0] op_sel_hi:[1,1,1]
    v_pk_fma_f32 v[80:81], v[56:57], v[144:145], v[80:81] op_sel:[0,0,0] op_sel_hi:[1,0,1]
    v_pk_fma_f32 v[82:83], v[58:59], v[144:145], v[82:83] op_sel:[0,0,0] op_sel_hi:[1,0,1]
    v_pk_fma_f32 v[84:85], v[60:61], v[146:147], v[84:85] op_sel:[0,0,0] op_sel_hi:[1,0,1]
    v_pk_fma_f32 v[86:87], v[62:63], v[146:147], v[86:87] op_sel:[0,0,0] op_sel_hi:[1,0,1]
    v_mul_f32 v56, v80, |v80|
    v_mul_f32 v57, v81, |v81|
    v_mul_f32 v58, v82, |v82|
    v_mul_f32 v59, v83, |v83|
    v_mul_f32 v60, v84, |v84|
    v_mul_f32 v61, v85, |v85|
    v_mul_f32 v62, v86, |v86|
    v_mul_f32 v63, v87, |v87|
    v_cvt_pk_bf16_f32 v68, v56, v57
    v_cvt_pk_bf16_f32 v69, v58, v59
    v_cvt_pk_bf16_f32 v70, v60, v61
    v_cvt_pk_bf16_f32 v71, v62, v63
    v_pk_max_i16 v68, v68, 0
    v_pk_max_i16 v69, v69, 0
    v_pk_max_i16 v70, v70, 0
    v_pk_max_i16 v71, v71, 0
    s_nop 0
    v_permlane16_swap_b32 v68, v70
    v_permlane16_swap_b32 v69, v71
    buffer_store_dwordx4 v[68:71], v11, s[56:59], s9 offen offset:2048 sc1
KF_GEPI:
    ds_write_b32 v7, v6 offset:192
    ds_write_b32 v7, v6 offset:144
    s_mov_b32 s52, s36
    s_mov_b32 s53, s37
    s_mov_b32 s54, 0x158000
    s_mov_b32 s55, 0x00020000
    s_mul_i32 s71, s12, 22
    s_lshl_b32 s70, s71, 14
    s_lshl_b32 s9, s68, 7
    s_add_u32 s70, s70, s9
    s_mul_i32 s64, s12, 4096
    s_mul_i32 s65, s12, 10240
    s_add_u32 s65, s65, 108544
    v_lshrrev_b32 v4, 3, v0
    v_and_b32 v5, 7, v0
    v_bfe_u32 v1, v0, 4, 1
    v_lshlrev_b32 v1, 2, v1
    v_xor_b32 v5, v5, v1
    v_lshlrev_b32 v4, 10, v4
    v_lshl_add_u32 v12, v5, 4, v4
    v_add_u32 v13, 8192, v12
    s_add_u32 s70, s70, 180224
    s_mul_i32 s9, s67, 172
    s_add_u32 s9, s9, s71
    s_lshl_b32 s72, s9, 10
    s_add_u32 s72, s72, 0
    s_add_u32 s73, s72, 88064
    v_lshrrev_b32 v4, 1, v10
    v_lshrrev_b32 v5, 2, v9
    v_lshl_add_u32 v4, v4, 3, v5
    v_lshlrev_b32 v4, 7, v4
    v_and_b32 v5, 1, v10
    v_lshl_add_u32 v4, v5, 5, v4
    v_and_b32 v5, 3, v9
    v_lshl_add_u32 v4, v5, 3, v4
    v_bfe_u32 v5, v9, 3, 1
    v_lshl_add_u32 v4, v5, 6, v4
    v_add_u32 v14, s64, v4
    v_add_u32 v12, s65, v4
    v_xor_b32 v4, 64, v4
    v_add_u32 v15, s64, v4
    v_add_u32 v13, s65, v4
SPIN_32:
    ds_read_b32 v4, v8 offset:172
    s_waitcnt lgkmcnt(0)
    v_readfirstlane_b32 s8, v4
    s_nop 0
    s_cmp_eq_u32 s8, 0
    s_cbranch_scc1 SPIN_32
    s_waitcnt vmcnt(0)
    s_mov_b64 exec, 1
    ds_add_rtn_u32 v4, v8, v6 offset:160
    v_mov_b32 v5, 0
    s_waitcnt lgkmcnt(0)
    v_readfirstlane_b32 s82, v4
    s_nop 0
    s_cmp_lg_u32 s82, 3
    s_cbranch_scc1 KF_PUBH
    buffer_store_dword v6, v5, s[56:59], s74 offen sc1
KF_PUBH:
    s_mov_b64 exec, -1
    s_setprio 1
    s_mov_b32 s83, 400000
    s_branch KF_POLLH_F
KF_POLLH:
    s_sleep 3
KF_POLLH_F:
    s_load_dwordx2 s[20:21], s[40:41], s75 glc
    s_waitcnt lgkmcnt(0)
    s_and_b32 s20, s20, s21
    s_sub_u32 s83, s83, 1
    s_cbranch_scc1 KF_POLLH_D
    s_cmp_lg_u32 s20, 1
    s_cbranch_scc1 KF_POLLH
KF_POLLH_D:
    buffer_load_dwordx4 v[80:83], v11, s[56:59], s72 offen offset:0 sc1
    buffer_load_dwordx4 v[84:87], v11, s[56:59], s73 offen offset:0 sc1
    buffer_load_dwordx4 v[88:91], v11, s[56:59], s72 offen offset:1024 sc1
    buffer_load_dwordx4 v[92:95], v11, s[56:59], s73 offen offset:1024 sc1
    buffer_load_dwordx4 v[96:99], v11, s[56:59], s72 offen offset:2048 sc1
    buffer_load_dwordx4 v[100:103], v11, s[56:59], s73 offen offset:2048 sc1
    buffer_load_dwordx4 v[104:107], v11, s[56:59], s72 offen offset:3072 sc1
    buffer_load_dwordx4 v[108:111], v11, s[56:59], s73 offen offset:3072 sc1
    s_add_u32 s72, s72, 4096
    s_add_u32 s73, s73, 4096
    buffer_load_dwordx4 v[112:115], v11, s[56:59], s72 offen offset:0 sc1
    buffer_load_dwordx4 v[116:119], v11, s[56:59], s73 offen offset:0 sc1
    buffer_load_dwordx4 v[120:123], v11, s[56:59], s72 offen offset:1024 sc1
    buffer_load_dwordx4 v[124:127], v11, s[56:59], s73 offen offset:1024 sc1
    buffer_load_dwordx4 v[128:131], v11, s[56:59], s72 offen offset:2048 sc1
    buffer_load_dwordx4 v[132:135], v11, s[56:59], s73 offen offset:2048 sc1
    buffer_load_dwordx4 v[136:139], v11, s[56:59], s72 offen offset:3072 sc1
    buffer_load_dwordx4 v[140:143], v11, s[56:59], s73 offen offset:3072 sc1
    s_add_u32 s72, s72, 4096
    s_add_u32 s73, s73, 4096
SPIN_33:
    ds_read_b32 v4, v7 offset:128
    s_waitcnt lgkmcnt(0)
    v_readfirstlane_b32 s8, v4
    s_nop 0
    s_cmp_eq_u32 s8, 0
    s_cbranch_scc1 SPIN_33
    ds_read_b64_tr_b16 v[144:145], v14 offset:0
    ds_read_b64_tr_b16 v[146:147], v14 offset:512
    ds_read_b64_tr_b16 v[148:149], v15 offset:0
    ds_read_b64_tr_b16 v[150:151], v15 offset:512
    s_waitcnt vmcnt(14)
    s_waitcnt lgkmcnt(0)
    ds_read_b64_tr_b16 v[152:153], v14 offset:2048
    ds_read_b64_tr_b16 v[154:155], v14 offset:2560
    ds_read_b64_tr_b16 v[156:157], v15 offset:2048
    ds_read_b64_tr_b16 v[158:159], v15 offset:2560
    v_mfma_f32_32x32x16_bf16 v[16:31], v[144:147], v[80:83], 0
    v_mfma_f32_32x32x16_bf16 v[32:47], v[144:147], v[84:87], 0
    v_mfma_f32_32x32x16_bf16 v[48:63], v[148:151], v[80:83], 0
    v_mfma_f32_32x32x16_bf16 v[64:79], v[148:151], v[84:87], 0
    s_waitcnt vmcnt(12)
    s_waitcnt lgkmcnt(0)
    ds_read_b64_tr_b16 v[144:145], v14 offset:16384
    ds_read_b64_tr_b16 v[146:147], v14 offset:16896
    ds_read_b64_tr_b16 v[148:149], v15 offset:16384
    ds_read_b64_tr_b16 v[150:151], v15 offset:16896
    v_mfma_f32_32x32x16_bf16 v[16:31], v[152:155], v[88:91], v[16:31]
    buffer_load_dwordx4 v[80:83], v11, s[56:59], s72 offen offset:0 sc1
    v_mfma_f32_32x32x16_bf16 v[32:47], v[152:155], v[92:95], v[32:47]
    buffer_load_dwordx4 v[84:87], v11, s[56:59], s73 offen offset:0 sc1
    v_mfma_f32_32x32x16_bf16 v[48:63], v[156:159], v[88:91], v[48:63]
    v_mfma_f32_32x32x16_bf16 v[64:79], v[156:159], v[92:95], v[64:79]
    s_waitcnt vmcnt(12)
    s_waitcnt lgkmcnt(0)
    ds_read_b64_tr_b16 v[152:153], v14 offset:18432
    ds_read_b64_tr_b16 v[154:155], v14 offset:18944
    ds_read_b64_tr_b16 v[156:157], v15 offset:18432
    ds_read_b64_tr_b16 v[158:159], v15 offset:18944
    v_mfma_f32_32x32x16_bf16 v[16:31], v[144:147], v[96:99], v[16:31]
    buffer_load_dwordx4 v[88:91], v11, s[56:59], s72 offen offset:1024 sc1
    v_mfma_f32_32x32x16_bf16 v[32:47], v[144:147], v[100:103], v[32:47]
    buffer_load_dwordx4 v[92:95], v11, s[56:59], s73 offen offset:1024 sc1
    v_mfma_f32_32x32x16_bf16 v[48:63], v[148:151], v[96:99], v[48:63]
    v_mfma_f32_32x32x16_bf16 v[64:79], v[148:151], v[100:103], v[64:79]
    s_waitcnt vmcnt(12)
    s_waitcnt lgkmcnt(0)
    ds_read_b64_tr_b16 v[144:145], v14 offset:32768
    ds_read_b64_tr_b16 v[146:147], v14 offset:33280
    ds_read_b64_tr_b16 v[148:149], v15 offset:32768
    ds_read_b64_tr_b16 v[150:151], v15 offset:33280
    v_mov_b32 v4, 1
    ds_write_b32 v7, v4 offset:208
    v_mfma_f32_32x32x16_bf16 v[16:31], v[152:155], v[104:107], v[16:31]
    buffer_load_dwordx4 v[96:99], v11, s[56:59], s72 offen offset:2048 sc1
    v_mfma_f32_32x32x16_bf16 v[32:47], v[152:155], v[108:111], v[32:47]
    buffer_load_dwordx4 v[100:103], v11, s[56:59], s73 offen offset:2048 sc1
    v_mfma_f32_32x32x16_bf16 v[48:63], v[156:159], v[104:107], v[48:63]
    v_mfma_f32_32x32x16_bf16 v[64:79], v[156:159], v[108:111], v[64:79]
    s_waitcnt vmcnt(12)
    s_waitcnt lgkmcnt(0)
    ds_read_b64_tr_b16 v[152:153], v14 offset:34816
    ds_read_b64_tr_b16 v[154:155], v14 offset:35328
    ds_read_b64_tr_b16 v[156:157], v15 offset:34816
    ds_read_b64_tr_b16 v[158:159], v15 offset:35328
    ds_read_b32 v5, v7 offset:224
    v_mfma_f32_32x32x16_bf16 v[16:31], v[144:147], v[112:115], v[16:31]
    buffer_load_dwordx4 v[104:107], v11, s[56:59], s72 offen offset:3072 sc1
    v_mfma_f32_32x32x16_bf16 v[32:47], v[144:147], v[116:119], v[32:47]
    buffer_load_dwordx4 v[108:111], v11, s[56:59], s73 offen offset:3072 sc1
    s_add_u32 s72, s72, 4096
    s_add_u32 s73, s73, 4096
    v_mfma_f32_32x32x16_bf16 v[48:63], v[148:151], v[112:115], v[48:63]
    v_mfma_f32_32x32x16_bf16 v[64:79], v[148:151], v[116:119], v[64:79]
    s_waitcnt vmcnt(12)
    s_waitcnt lgkmcnt(0)
    v_readfirstlane_b32 s8, v5
    s_nop 0
    s_cmp_lt_u32 s8, 1
    s_cbranch_scc1 WSLOW_34
WBACK_35:
    ds_read_b64_tr_b16 v[144:145], v12 offset:0
    ds_read_b64_tr_b16 v[146:147], v12 offset:512
    ds_read_b64_tr_b16 v[148:149], v13 offset:0
    ds_read_b64_tr_b16 v[150:151], v13 offset:512
    v_mfma_f32_32x32x16_bf16 v[16:31], v[152:155], v[120:123], v[16:31]
    buffer_load_dwordx4 v[112:115], v11, s[56:59], s72 offen offset:0 sc1
    v_mfma_f32_32x32x16_bf16 v[32:47], v[152:155], v[124:127], v[32:47]
    buffer_load_dwordx4 v[116:119], v11, s[56:59], s73 offen offset:0 sc1
    v_mfma_f32_32x32x16_bf16 v[48:63], v[156:159], v[120:123], v[48:63]
    v_mfma_f32_32x32x16_bf16 v[64:79], v[156:159], v[124:127], v[64:79]
    s_waitcnt vmcnt(12)
    s_waitcnt lgkmcnt(0)
    ds_read_b64_tr_b16 v[152:153], v12 offset:2048
    ds_read_b64_tr_b16 v[154:155], v12 offset:2560
    ds_read_b64_tr_b16 v[156:157], v13 offset:2048
    ds_read_b64_tr_b16 v[158:159], v13 offset:2560
    v_mfma_f32_32x32x16_bf16 v[16:31], v[144:147], v[128:131], v[16:31]
    buffer_load_dwordx4 v[120:123], v11, s[56:59], s72 offen offset:1024 sc1
    v_mfma_f32_32x32x16_bf16 v[32:47], v[144:147], v[132:135], v[32:47]
    buffer_load_dwordx4 v[124:127], v11, s[56:59], s73 offen offset:1024 sc1
    v_mfma_f32_32x32x16_bf16 v[48:63], v[148:151], v[128:131], v[48:63]
    v_mfma_f32_32x32x16_bf16 v[64:79], v[148:151], v[132:135], v[64:79]
    s_waitcnt vmcnt(12)
    s_waitcnt lgkmcnt(0)
    ds_read_b64_tr_b16 v[144:145], v12 offset:4096
    ds_read_b64_tr_b16 v[146:147], v12 offset:4608
    ds_read_b64_tr_b16 v[148:149], v13 offset:4096
    ds_read_b64_tr_b16 v[150:151], v13 offset:4608
    v_mov_b32 v4, 2
    ds_write_b32 v7, v4 offset:208
    v_mfma_f32_32x32x16_bf16 v[16:31], v[152:155], v[136:139], v[16:31]
    buffer_load_dwordx4 v[128:131], v11, s[56:59], s72 offen offset:2048 sc1
    v_mfma_f32_32x32x16_bf16 v[32:47], v[152:155], v[140:143], v[32:47]
    buffer_load_dwordx4 v[132:135], v11, s[56:59], s73 offen offset:2048 sc1
    v_mfma_f32_32x32x16_bf16 v[48:63], v[156:159], v[136:139], v[48:63]
    v_mfma_f32_32x32x16_bf16 v[64:79], v[156:159], v[140:143], v[64:79]
    s_waitcnt vmcnt(12)
    s_waitcnt lgkmcnt(0)
    ds_read_b64_tr_b16 v[152:153], v12 offset:6144
    ds_read_b64_tr_b16 v[154:155], v12 offset:6656
    ds_read_b64_tr_b16 v[156:157], v13 offset:6144
    ds_read_b64_tr_b16 v[158:159], v13 offset:6656
    v_mfma_f32_32x32x16_bf16 v[16:31], v[144:147], v[80:83], v[16:31]
    buffer_load_dwordx4 v[136:139], v11, s[56:59], s72 offen offset:3072 sc1
    v_mfma_f32_32x32x16_bf16 v[32:47], v[144:147], v[84:87], v[32:47]
    buffer_load_dwordx4 v[140:143], v11, s[56:59], s73 offen offset:3072 sc1
    s_add_u32 s72, s72, 4096
    s_add_u32 s73, s73, 4096
    v_mfma_f32_32x32x16_bf16 v[48:63], v[148:151], v[80:83], v[48:63]
    v_mfma_f32_32x32x16_bf16 v[64:79], v[148:151], v[84:87], v[64:79]
    s_waitcnt vmcnt(12)
    s_waitcnt lgkmcnt(0)
    ds_read_b64_tr_b16 v[144:145], v12 offset:8192
    ds_read_b64_tr_b16 v[146:147], v12 offset:8704
    ds_read_b64_tr_b16 v[148:149], v13 offset:8192
    ds_read_b64_tr_b16 v[150:151], v13 offset:8704
    ds_read_b32 v5, v7 offset:224
    v_mfma_f32_32x32x16_bf16 v[16:31], v[152:155], v[88:91], v[16:31]
    buffer_load_dwordx4 v[80:83], v11, s[56:59], s72 offen offset:0 sc1
    v_mfma_f32_32x32x16_bf16 v[32:47], v[152:155], v[92:95], v[32:47]
    buffer_load_dwordx4 v[84:87], v11, s[56:59], s73 offen offset:0 sc1
    v_mfma_f32_32x32x16_bf16 v[48:63], v[156:159], v[88:91], v[48:63]
    v_mfma_f32_32x32x16_bf16 v[64:79], v[156:159], v[92:95], v[64:79]
    s_waitcnt vmcnt(12)
    s_waitcnt lgkmcnt(0)
    v_readfirstlane_b32 s8, v5
    s_nop 0
    s_cmp_lt_u32 s8, 2
    s_cbranch_scc1 WSLOW_36
WBACK_37:
    ds_read_b64_tr_b16 v[152:153], v14 offset:0
    ds_read_b64_tr_b16 v[154:155], v14 offset:512
    ds_read_b64_tr_b16 v[156:157], v15 offset:0
    ds_read_b64_tr_b16 v[158:159], v15 offset:512
    v_mov_b32 v4, 3
    ds_write_b32 v7, v4 offset:208
    v_mfma_f32_32x32x16_bf16 v[16:31], v[144:147], v[96:99], v[16:31]
    buffer_load_dwordx4 v[88:91], v11, s[56:59], s72 offen offset:1024 sc1
    v_mfma_f32_32x32x16_bf16 v[32:47], v[144:147], v[100:103], v[32:47]
    buffer_load_dwordx4 v[92:95], v11, s[56:59], s73 offen offset:1024 sc1
    v_mfma_f32_32x32x16_bf16 v[48:63], v[148:151], v[96:99], v[48:63]
    v_mfma_f32_32x32x16_bf16 v[64:79], v[148:151], v[100:103], v[64:79]
    s_waitcnt vmcnt(12)
    s_waitcnt lgkmcnt(0)
    ds_read_b64_tr_b16 v[144:145], v14 offset:2048
    ds_read_b64_tr_b16 v[146:147], v14 offset:2560
    ds_read_b64_tr_b16 v[148:149], v15 offset:2048
    ds_read_b64_tr_b16 v[150:151], v15 offset:2560
    v_mfma_f32_32x32x16_bf16 v[16:31], v[152:155], v[104:107], v[16:31]
    buffer_load_dwordx4 v[96:99], v11, s[56:59], s72 offen offset:2048 sc1
    v_mfma_f32_32x32x16_bf16 v[32:47], v[152:155], v[108:111], v[32:47]
    buffer_load_dwordx4 v[100:103], v11, s[56:59], s73 offen offset:2048 sc1
    v_mfma_f32_32x32x16_bf16 v[48:63], v[156:159], v[104:107], v[48:63]
    v_mfma_f32_32x32x16_bf16 v[64:79], v[156:159], v[108:111], v[64:79]
    s_waitcnt vmcnt(12)
    s_waitcnt lgkmcnt(0)
    ds_read_b64_tr_b16 v[152:153], v14 offset:16384
    ds_read_b64_tr_b16 v[154:155], v14 offset:16896
    ds_read_b64_tr_b16 v[156:157], v15 offset:16384
    ds_read_b64_tr_b16 v[158:159], v15 offset:16896
    v_mfma_f32_32x32x16_bf16 v[16:31], v[144:147], v[112:115], v[16:31]
    buffer_load_dwordx4 v[104:107], v11, s[56:59], s72 offen offset:3072 sc1
    v_mfma_f32_32x32x16_bf16 v[32:47], v[144:147], v[116:119], v[32:47]
    buffer_load_dwordx4 v[108:111], v11, s[56:59], s73 offen offset:3072 sc1
    s_add_u32 s72, s72, 4096
    s_add_u32 s73, s73, 4096
    v_mfma_f32_32x32x16_bf16 v[48:63], v[148:151], v[112:115], v[48:63]
    v_mfma_f32_32x32x16_bf16 v[64:79], v[148:151], v[116:119], v[64:79]
    s_waitcnt vmcnt(12)
    s_waitcnt lgkmcnt(0)
    ds_read_b64_tr_b16 v[144:145], v14 offset:18432
    ds_read_b64_tr_b16 v[146:147], v14 offset:18944
    ds_read_b64_tr_b16 v[148:149], v15 offset:18432
    ds_read_b64_tr_b16 v[150:151], v15 offset:18944
    ds_read_b32 v5, v7 offset:224
    v_mfma_f32_32x32x16_bf16 v[16:31], v[152:155], v[120:123], v[16:31]
    buffer_load_dwordx4 v[112:115], v11, s[56:59], s72 offen offset:0 sc1
    v_mfma_f32_32x32x16_bf16 v[32:47], v[152:155], v[124:127], v[32:47]
    buffer_load_dwordx4 v[116:119], v11, s[56:59], s73 offen offset:0 sc1
    v_mfma_f32_32x32x16_bf16 v[48:63], v[156:159], v[120:123], v[48:63]
    v_mfma_f32_32x32x16_bf16 v[64:79], v[156:159], v[124:127], v[64:79]
    s_waitcnt vmcnt(12)
    s_waitcnt lgkmcnt(0)
    v_readfirstlane_b32 s8, v5
    s_nop 0
    s_cmp_lt_u32 s8, 3
    s_cbranch_scc1 WSLOW_38
WBACK_39:
    ds_read_b64_tr_b16 v[152:153], v14 offset:32768
    ds_read_b64_tr_b16 v[154:155], v14 offset:33280
    ds_read_b64_tr_b16 v[156:157], v15 offset:32768
    ds_read_b64_tr_b16 v[158:159], v15 offset:33280
    ds_write_b32 v8, v6 offset:188
    v_mfma_f32_32x32x16_bf16 v[16:31], v[144:147], v[128:131], v[16:31]
    buffer_load_dwordx4 v[120:123], v11, s[56:59], s72 offen offset:1024 sc1
    v_mfma_f32_32x32x16_bf16 v[32:47], v[144:147], v[132:135], v[32:47]
    buffer_load_dwordx4 v[124:127], v11, s[56:59], s73 offen offset:1024 sc1
    v_mfma_f32_32x32x16_bf16 v[48:63], v[148:151], v[128:131], v[48:63]
    v_mfma_f32_32x32x16_bf16 v[64:79], v[148:151], v[132:135], v[64:79]
    s_waitcnt vmcnt(12)
    s_waitcnt lgkmcnt(0)
    ds_read_b64_tr_b16 v[144:145], v14 offset:34816
    ds_read_b64_tr_b16 v[146:147], v14 offset:35328
    ds_read_b64_tr_b16 v[148:149], v15 offset:34816
    ds_read_b64_tr_b16 v[150:151], v15 offset:35328
    v_mfma_f32_32x32x16_bf16 v[16:31], v[152:155], v[136:139], v[16:31]
    v_mfma_f32_32x32x16_bf16 v[32:47], v[152:155], v[140:143], v[32:47]
    v_mfma_f32_32x32x16_bf16 v[48:63], v[156:159], v[136:139], v[48:63]
    v_mfma_f32_32x32x16_bf16 v[64:79], v[156:159], v[140:143], v[64:79]
    s_waitcnt vmcnt(10)
    s_waitcnt lgkmcnt(0)
    ds_read_b64_tr_b16 v[152:153], v12 offset:0
    ds_read_b64_tr_b16 v[154:155], v12 offset:512
    ds_read_b64_tr_b16 v[156:157], v13 offset:0
    ds_read_b64_tr_b16 v[158:159], v13 offset:512
    s_lshl_b32 s8, s68, 7
    s_add_u32 s8, s8, 64
    v_lshlrev_b32 v2, 4, v10
    v_add_u32 v2, s8, v2
    s_lshl_b32 s8, s67, 6
    s_lshl_b32 s9, s12, 4
    s_add_u32 s8, s8, s9
    v_add_u32 v3, s8, v9
    v_lshl_add_u32 v3, v3, 10, v2
    global_load_dwordx4 v[160:163], v3, s[16:17]
    v_mfma_f32_32x32x16_bf16 v[16:31], v[144:147], v[80:83], v[16:31]
    v_mfma_f32_32x32x16_bf16 v[32:47], v[144:147], v[84:87], v[32:47]
    v_mfma_f32_32x32x16_bf16 v[48:63], v[148:151], v[80:83], v[48:63]
    v_mfma_f32_32x32x16_bf16 v[64:79], v[148:151], v[84:87], v[64:79]
    s_waitcnt vmcnt(9)
    s_waitcnt lgkmcnt(0)
    ds_read_b64_tr_b16 v[144:145], v12 offset:2048
    ds_read_b64_tr_b16 v[146:147], v12 offset:2560
    ds_read_b64_tr_b16 v[148:149], v13 offset:2048
    ds_read_b64_tr_b16 v[150:151], v13 offset:2560
    ds_read_b32 v5, v7 offset:224
    v_mfma_f32_32x32x16_bf16 v[16:31], v[152:155], v[88:91], v[16:31]
    v_mfma_f32_32x32x16_bf16 v[32:47], v[152:155], v[92:95], v[32:47]
    v_mfma_f32_32x32x16_bf16 v[48:63], v[156:159], v[88:91], v[48:63]
    v_mfma_f32_32x32x16_bf16 v[64:79], v[156:159], v[92:95], v[64:79]
    s_waitcnt vmcnt(7)
    s_waitcnt lgkmcnt(0)
    v_readfirstlane_b32 s8, v5
    s_nop 0
    s_cmp_lt_u32 s8, 4
    s_cbranch_scc1 WSLOW_40
WBACK_41:
    ds_read_b64_tr_b16 v[152:153], v12 offset:4096
    ds_read_b64_tr_b16 v[154:155], v12 offset:4608
    ds_read_b64_tr_b16 v[156:157], v13 offset:4096
    ds_read_b64_tr_b16 v[158:159], v13 offset:4608
    v_mfma_f32_32x32x16_bf16 v[16:31], v[144:147], v[96:99], v[16:31]
    v_mfma_f32_32x32x16_bf16 v[32:47], v[144:147], v[100:103], v[32:47]
    v_mfma_f32_32x32x16_bf16 v[48:63], v[148:151], v[96:99], v[48:63]
    v_mfma_f32_32x32x16_bf16 v[64:79], v[148:151], v[100:103], v[64:79]
    s_waitcnt vmcnt(5)
    s_waitcnt lgkmcnt(0)
    ds_read_b64_tr_b16 v[144:145], v12 offset:6144
    ds_read_b64_tr_b16 v[146:147], v12 offset:6656
    ds_read_b64_tr_b16 v[148:149], v13 offset:6144
    ds_read_b64_tr_b16 v[150:151], v13 offset:6656
    v_and_b32 v4, 31, v0
    v_lshrrev_b32 v5, 5, v0
    v_and_b32 v1, 7, v0
    v_xor_b32 v5, v5, v1
    v_lshlrev_b32 v5, 4, v5
    v_lshl_add_u32 v4, v4, 7, v5
    v_xor_b32 v5, 0, v4
    v_add_u32 v136, s64, v5
    v_add_u32 v140, s65, v5
    v_xor_b32 v5, 32, v4
    v_add_u32 v137, s64, v5
    v_add_u32 v141, s65, v5
    v_xor_b32 v5, 64, v4
    v_add_u32 v138, s64, v5
    v_add_u32 v142, s65, v5
    v_xor_b32 v5, 96, v4
    v_add_u32 v139, s64, v5
    v_add_u32 v143, s65, v5
    v_mfma_f32_32x32x16_bf16 v[16:31], v[152:155], v[104:107], v[16:31]
    v_mfma_f32_32x32x16_bf16 v[32:47], v[152:155], v[108:111], v[32:47]
    v_mfma_f32_32x32x16_bf16 v[48:63], v[156:159], v[104:107], v[48:63]
    v_mfma_f32_32x32x16_bf16 v[64:79], v[156:159], v[108:111], v[64:79]
    s_waitcnt vmcnt(3)
    s_waitcnt lgkmcnt(0)
    ds_read_b64_tr_b16 v[152:153], v12 offset:8192
    ds_read_b64_tr_b16 v[154:155], v12 offset:8704
    ds_read_b64_tr_b16 v[156:157], v13 offset:8192
    ds_read_b64_tr_b16 v[158:159], v13 offset:8704
    s_cmp_eq_u32 s12, 3
    s_cbranch_scc1 KF_GDONE
    v_mfma_f32_32x32x16_bf16 v[16:31], v[144:147], v[112:115], v[16:31]
    v_mfma_f32_32x32x16_bf16 v[32:47], v[144:147], v[116:119], v[32:47]
    v_mfma_f32_32x32x16_bf16 v[48:63], v[148:151], v[112:115], v[48:63]
    v_mfma_f32_32x32x16_bf16 v[64:79], v[148:151], v[116:119], v[64:79]
    s_waitcnt vmcnt(1)
    s_waitcnt lgkmcnt(0)
    v_mfma_f32_32x32x16_bf16 v[16:31], v[152:155], v[120:123], v[16:31]
    v_mfma_f32_32x32x16_bf16 v[32:47], v[152:155], v[124:127], v[32:47]
    v_mfma_f32_32x32x16_bf16 v[48:63], v[156:159], v[120:123], v[48:63]
    v_mfma_f32_32x32x16_bf16 v[64:79], v[156:159], v[124:127], v[64:79]
KF_GDONE:
    s_waitcnt lgkmcnt(0)
    s_nop 7
    s_nop 3
    ds_write_b128 v136, v[16:19] offset:0
    ds_write_b128 v136, v[48:51] offset:16384
    ds_write_b128 v140, v[32:35] offset:0
    ds_write_b128 v140, v[64:67] offset:4096
    ds_write_b128 v137, v[20:23] offset:0
    ds_write_b128 v137, v[52:55] offset:16384
    ds_write_b128 v141, v[36:39] offset:0
    ds_write_b128 v141, v[68:71] offset:4096
    ds_write_b128 v138, v[24:27] offset:0
    ds_write_b128 v138, v[56:59] offset:16384
    ds_write_b128 v142, v[40:43] offset:0
    ds_write_b128 v142, v[72:75] offset:4096
    ds_write_b128 v139, v[28:31] offset:0
    ds_write_b128 v139, v[60:63] offset:16384
    ds_write_b128 v143, v[44:47] offset:0
    ds_write_b128 v143, v[76:79] offset:4096
    s_mov_b32 s13, 1
KF_FINAL:
    s_and_b32 s8, s12, 1
    s_lshl_b32 s8, s8, 11
    v_lshlrev_b32 v98, 1, v10
    v_and_b32 v99, 7, v9
    v_xor_b32 v98, v98, v99
    v_lshlrev_b32 v98, 4, v98
    v_lshl_add_u32 v98, v9, 7, v98
    s_lshl_b32 s9, s13, 14
    s_lshl_b32 s10, s13, 12
    s_add_u32 s10, s10, 108544
    s_cmp_ge_u32 s12, 2
    s_cselect_b32 s9, s10, s9
    s_mov_b32 s10, 4096
    s_cselect_b32 s10, 10240, s10
    s_add_u32 s8, s8, s9
    v_add_u32 v100, s8, v98
    v_xor_b32 v98, 16, v98
    v_add_u32 v104, s8, v98
    v_add_u32 v101, s10, v100
    v_add_u32 v105, s10, v104
    v_add_u32 v102, s10, v101
    v_add_u32 v106, s10, v105
    v_add_u32 v103, s10, v102
    v_add_u32 v107, s10, v106
    v_lshrrev_b32 v97, 2, v9
    v_and_b32 v98, 1, v10
    v_lshl_add_u32 v97, v98, 3, v97
    v_mul_u32_u24 v97, 144, v97
    v_and_b32 v98, 3, v9
    v_lshl_add_u32 v97, v98, 3, v97
    v_lshrrev_b32 v98, 1, v10
    v_xor_b32 v98, 1, v98
    v_lshl_add_u32 v97, v98, 12, v97
    s_lshl_b32 s8, s13, 13
    s_lshl_b32 s9, s12, 5
    s_add_u32 s8, s8, s9
    s_add_u32 s8, s8, 92160
    v_add_u32 v97, s8, v97
    s_waitcnt vmcnt(0)
    v_lshlrev_b32 v80, 16, v160
    v_and_b32 v81, 0xffff0000, v160
    v_lshlrev_b32 v88, 16, v164
    v_and_b32 v89, 0xffff0000, v164
    v_lshlrev_b32 v82, 16, v161
    v_and_b32 v83, 0xffff0000, v161
    v_lshlrev_b32 v90, 16, v165
    v_and_b32 v91, 0xffff0000, v165
    v_lshlrev_b32 v84, 16, v162
    v_and_b32 v85, 0xffff0000, v162
    v_lshlrev_b32 v92, 16, v166
    v_and_b32 v93, 0xffff0000, v166
    v_lshlrev_b32 v86, 16, v163
    v_and_b32 v87, 0xffff0000, v163
    v_lshlrev_b32 v94, 16, v167
    v_and_b32 v95, 0xffff0000, v167
    v_add_f32 v80, v80, v88
    v_add_f32 v81, v81, v89
    v_add_f32 v82, v82, v90
    v_add_f32 v83, v83, v91
    v_add_f32 v84, v84, v92
    v_add_f32 v85, v85, v93
    v_add_f32 v86, v86, v94
    v_add_f32 v87, v87, v95
    s_waitcnt lgkmcnt(0)
    s_barrier
    ds_read_b64_tr_b16 v[20:21], v97
    ds_read_b64_tr_b16 v[22:23], v97 offset:576
    ds_read_b128 v[24:27], v100
    ds_read_b128 v[28:31], v104
    ds_read_b128 v[32:35], v101
    ds_read_b128 v[36:39], v105
    ds_read_b128 v[40:43], v102
    ds_read_b128 v[44:47], v106
    ds_read_b128 v[48:51], v103
    ds_read_b128 v[52:55], v107
    s_waitcnt lgkmcnt(8)
    v_lshlrev_b32 v88, 16, v20
    v_and_b32 v89, 0xffff0000, v20
    v_lshlrev_b32 v90, 16, v21
    v_and_b32 v91, 0xffff0000, v21
    v_lshlrev_b32 v92, 16, v22
    v_and_b32 v93, 0xffff0000, v22
    v_lshlrev_b32 v94, 16, v23
    v_and_b32 v95, 0xffff0000, v23
    v_pk_add_f32 v[80:81], v[80:81], v[88:89]
    v_pk_add_f32 v[82:83], v[82:83], v[90:91]
    v_pk_add_f32 v[84:85], v[84:85], v[92:93]
    v_pk_add_f32 v[86:87], v[86:87], v[94:95]
    s_waitcnt lgkmcnt(6)
    v_pk_add_f32 v[80:81], v[80:81], v[24:25]
    v_pk_add_f32 v[82:83], v[82:83], v[26:27]
    v_pk_add_f32 v[84:85], v[84:85], v[28:29]
    v_pk_add_f32 v[86:87], v[86:87], v[30:31]
    s_waitcnt lgkmcnt(4)
    v_pk_add_f32 v[80:81], v[80:81], v[32:33]
    v_pk_add_f32 v[82:83], v[82:83], v[34:35]
    v_pk_add_f32 v[84:85], v[84:85], v[36:37]
    v_pk_add_f32 v[86:87], v[86:87], v[38:39]
    s_waitcnt lgkmcnt(2)
    v_pk_add_f32 v[80:81], v[80:81], v[40:41]
    v_pk_add_f32 v[82:83], v[82:83], v[42:43]
    v_pk_add_f32 v[84:85], v[84:85], v[44:45]
    v_pk_add_f32 v[86:87], v[86:87], v[46:47]
    s_waitcnt lgkmcnt(0)
    v_pk_add_f32 v[80:81], v[80:81], v[48:49]
    v_pk_add_f32 v[82:83], v[82:83], v[50:51]
    v_pk_add_f32 v[84:85], v[84:85], v[52:53]
    v_pk_add_f32 v[86:87], v[86:87], v[54:55]
    v_cvt_pk_bf16_f32 v20, v80, v81
    v_cvt_pk_bf16_f32 v21, v82, v83
    v_cvt_pk_bf16_f32 v22, v84, v85
    v_cvt_pk_bf16_f32 v23, v86, v87
    global_store_dwordx4 v3, v[20:23], s[60:61] sc1
    s_branch KF_FIN
GSLOW_3:
SPIN_42:
    ds_read_b128 v[152:155], v8 offset:0
    s_waitcnt lgkmcnt(0)
    v_min3_u32 v152, v152, v153, v154
    v_min_u32 v152, v152, v155
    s_nop 0
    v_readfirstlane_b32 s8, v152
    s_nop 0
    s_cmp_lt_u32 s8, 3
    s_cbranch_scc1 SPIN_42
    s_branch GBACK_4
GSLOW_5:
SPIN_43:
    ds_read_b128 v[152:155], v8 offset:0
    s_waitcnt lgkmcnt(0)
    v_min3_u32 v152, v152, v153, v154
    v_min_u32 v152, v152, v155
    s_nop 0
    v_readfirstlane_b32 s8, v152
    s_nop 0
    s_cmp_lt_u32 s8, 4
    s_cbranch_scc1 SPIN_43
    s_branch GBACK_6
GSLOW_7:
SPIN_44:
    ds_read_b128 v[152:155], v8 offset:0
    s_waitcnt lgkmcnt(0)
    v_min3_u32 v152, v152, v153, v154
    v_min_u32 v152, v152, v155
    s_nop 0
    v_readfirstlane_b32 s8, v152
    s_nop 0
    s_cmp_lt_u32 s8, 5
    s_cbranch_scc1 SPIN_44
    s_branch GBACK_8
GSLOW_9:
SPIN_45:
    ds_read_b128 v[152:155], v8 offset:0
    s_waitcnt lgkmcnt(0)
    v_min3_u32 v152, v152, v153, v154
    v_min_u32 v152, v152, v155
    s_nop 0
    v_readfirstlane_b32 s8, v152
    s_nop 0
    s_cmp_lt_u32 s8, 6
    s_cbranch_scc1 SPIN_45
    s_branch GBACK_10
GSLOW_11:
SPIN_46:
    ds_read_b128 v[152:155], v8 offset:0
    s_waitcnt lgkmcnt(0)
    v_min3_u32 v152, v152, v153, v154
    v_min_u32 v152, v152, v155
    s_nop 0
    v_readfirstlane_b32 s8, v152
    s_nop 0
    s_cmp_lt_u32 s8, 7
    s_cbranch_scc1 SPIN_46
    s_branch GBACK_12
GSLOW_13:
SPIN_47:
    ds_read_b128 v[152:155], v8 offset:0
    s_waitcnt lgkmcnt(0)
    v_min3_u32 v152, v152, v153, v154
    v_min_u32 v152, v152, v155
    s_nop 0
    v_readfirstlane_b32 s8, v152
    s_nop 0
    s_cmp_lt_u32 s8, 8
    s_cbranch_scc1 SPIN_47
    s_branch GBACK_14
GSLOW_15:
SPIN_48:
    ds_read_b128 v[152:155], v8 offset:0
    s_waitcnt lgkmcnt(0)
    v_min3_u32 v152, v152, v153, v154
    v_min_u32 v152, v152, v155
    s_nop 0
    v_readfirstlane_b32 s8, v152
    s_nop 0
    s_cmp_lt_u32 s8, 9
    s_cbranch_scc1 SPIN_48
    s_branch GBACK_16
GSLOW_17:
SPIN_49:
    ds_read_b128 v[152:155], v8 offset:0
    s_waitcnt lgkmcnt(0)
    v_min3_u32 v152, v152, v153, v154
    v_min_u32 v152, v152, v155
    s_nop 0
    v_readfirstlane_b32 s8, v152
    s_nop 0
    s_cmp_lt_u32 s8, 10
    s_cbranch_scc1 SPIN_49
    s_branch GBACK_18
GSLOW_19:
SPIN_50:
    ds_read_b128 v[152:155], v8 offset:0
    s_waitcnt lgkmcnt(0)
    v_min3_u32 v152, v152, v153, v154
    v_min_u32 v152, v152, v155
    s_nop 0
    v_readfirstlane_b32 s8, v152
    s_nop 0
    s_cmp_lt_u32 s8, 11
    s_cbranch_scc1 SPIN_50
    s_branch GBACK_20
GSLOW_21:
SPIN_51:
    ds_read_b128 v[152:155], v8 offset:0
    s_waitcnt lgkmcnt(0)
    v_min3_u32 v152, v152, v153, v154
    v_min_u32 v152, v152, v155
    s_nop 0
    v_readfirstlane_b32 s8, v152
    s_nop 0
    s_cmp_lt_u32 s8, 12
    s_cbranch_scc1 SPIN_51
    s_branch GBACK_22
GSLOW_23:
SPIN_52:
    ds_read_b128 v[152:155], v8 offset:0
    s_waitcnt lgkmcnt(0)
    v_min3_u32 v152, v152, v153, v154
    v_min_u32 v152, v152, v155
    s_nop 0
    v_readfirstlane_b32 s8, v152
    s_nop 0
    s_cmp_lt_u32 s8, 13
    s_cbranch_scc1 SPIN_52
    s_branch GBACK_24
GSLOW_25:
SPIN_53:
    ds_read_b128 v[152:155], v8 offset:0
    s_waitcnt lgkmcnt(0)
    v_min3_u32 v152, v152, v153, v154
    v_min_u32 v152, v152, v155
    s_nop 0
    v_readfirstlane_b32 s8, v152
    s_nop 0
    s_cmp_lt_u32 s8, 14
    s_cbranch_scc1 SPIN_53
    s_branch GBACK_26
GSLOW_27:
SPIN_54:
    ds_read_b128 v[152:155], v8 offset:0
    s_waitcnt lgkmcnt(0)
    v_min3_u32 v152, v152, v153, v154
    v_min_u32 v152, v152, v155
    s_nop 0
    v_readfirstlane_b32 s8, v152
    s_nop 0
    s_cmp_lt_u32 s8, 15
    s_cbranch_scc1 SPIN_54
    s_branch GBACK_28
GSLOW_29:
SPIN_55:
    ds_read_b128 v[152:155], v8 offset:0
    s_waitcnt lgkmcnt(0)
    v_min3_u32 v152, v152, v153, v154
    v_min_u32 v152, v152, v155
    s_nop 0
    v_readfirstlane_b32 s8, v152
    s_nop 0
    s_cmp_lt_u32 s8, 16
    s_cbranch_scc1 SPIN_55
    s_branch GBACK_30
WSLOW_34:
    ds_read_b32 v5, v7 offset:224
    s_waitcnt lgkmcnt(0)
    v_readfirstlane_b32 s8, v5
    s_nop 0
    s_cmp_lt_u32 s8, 1
    s_cbranch_scc1 WSLOW_34
    s_branch WBACK_35
WSLOW_36:
    ds_read_b32 v5, v7 offset:224
    s_waitcnt lgkmcnt(0)
    v_readfirstlane_b32 s8, v5
    s_nop 0
    s_cmp_lt_u32 s8, 2
    s_cbranch_scc1 WSLOW_36
    s_branch WBACK_37
WSLOW_38:
    ds_read_b32 v5, v7 offset:224
    s_waitcnt lgkmcnt(0)
    v_readfirstlane_b32 s8, v5
    s_nop 0
    s_cmp_lt_u32 s8, 3
    s_cbranch_scc1 WSLOW_38
    s_branch WBACK_39
WSLOW_40:
    ds_read_b32 v5, v7 offset:224
    s_waitcnt lgkmcnt(0)
    v_readfirstlane_b32 s8, v5
    s_nop 0
    s_cmp_lt_u32 s8, 4
    s_cbranch_scc1 WSLOW_40
    s_branch WBACK_41
KF_L:
    s_lshl_b32 s13, s6, 6
    s_mul_i32 s14, s12, 192
    s_lshl_b32 s11, s4, 16
    s_lshl_b32 s10, s12, 14
    s_add_u32 s11, s11, s10
    s_lshl_b32 s10, s12, 12
    v_add_u32 v12, 0, v10
    v_xor_b32 v13, v12, v9
    v_lshlrev_b32 v13, 4, v13
    v_lshl_add_u32 v16, v12, 10, v13
    v_lshl_add_u32 v20, v9, 8, v13
    v_add_u32 v20, s10, v20
    v_add_u32 v12, 4, v10
    v_xor_b32 v13, v12, v9
    v_lshlrev_b32 v13, 4, v13
    v_lshl_add_u32 v17, v12, 10, v13
    v_lshl_add_u32 v21, v9, 8, v13
    v_add_u32 v21, s10, v21
    v_add_u32 v12, 8, v10
    v_xor_b32 v13, v12, v9
    v_lshlrev_b32 v13, 4, v13
    v_lshl_add_u32 v18, v12, 10, v13
    v_lshl_add_u32 v22, v9, 8, v13
    v_add_u32 v22, s10, v22
    v_add_u32 v12, 12, v10
    v_xor_b32 v13, v12, v9
    v_lshlrev_b32 v13, 4, v13
    v_lshl_add_u32 v19, v12, 10, v13
    v_lshl_add_u32 v23, v9, 8, v13
    v_add_u32 v23, s10, v23
    s_add_u32 s8, s80, 0
    s_and_b32 s8, s8, 3
    s_mul_i32 s76, s8, 352256
    s_lshl_b32 s8, s8, 8
    s_add_u32 s72, s11, s8
    s_add_u32 s8, s80, 1
    s_and_b32 s8, s8, 3
    s_mul_i32 s77, s8, 352256
    s_lshl_b32 s8, s8, 8
    s_add_u32 s73, s11, s8
    s_add_u32 s8, s80, 2
    s_and_b32 s8, s8, 3
    s_mul_i32 s78, s8, 352256
    s_lshl_b32 s8, s8, 8
    s_add_u32 s74, s11, s8
    s_add_u32 s8, s80, 3
    s_and_b32 s8, s8, 3
    s_mul_i32 s79, s8, 352256
    s_lshl_b32 s8, s8, 8
    s_add_u32 s75, s11, s8
    s_waitcnt lgkmcnt(0)
    s_mov_b32 s44, s16
    s_mov_b32 s45, s17
    s_mov_b32 s46, 0x200000
    s_mov_b32 s47, 0x00020000
    s_setprio 2
    s_add_u32 m0, s10, 0
    s_nop 0
    buffer_load_dwordx4 v16, s[44:47], s72 offen lds
    s_add_u32 m0, s10, 1024
    s_nop 0
    buffer_load_dwordx4 v17, s[44:47], s72 offen lds
    s_add_u32 m0, s10, 2048
    s_nop 0
    buffer_load_dwordx4 v18, s[44:47], s72 offen lds
    s_add_u32 m0, s10, 3072
    s_nop 0
    buffer_load_dwordx4 v19, s[44:47], s72 offen lds
    s_mov_b32 s48, s32
    s_mov_b32 s49, s33
    s_mov_b32 s50, 0x158000
    s_mov_b32 s51, 0x00020000
    s_lshr_b32 s26, 213, s5
    s_bitcmp1_b32 s26, 0
    s_cselect_b32 s26, 20, 24
    s_add_u32 s8, s14, 0
    v_add_u32 v28, s8, v0
    v_mul_u32_u24 v12, 2731, v28
    v_lshrrev_b32 v12, 16, v12
    v_mul_u32_u24 v13, 24, v12
    v_sub_u32 v13, v28, v13
    v_bfe_u32 v14, v12, 1, 2
    v_lshlrev_b32 v14, 1, v14
    v_xor_b32 v13, v13, v14
    v_bfe_u32 v14, v12, 2, 2
    v_lshlrev_b32 v14, 3, v14
    v_lshrrev_b32 v15, 4, v12
    v_lshl_add_u32 v14, v15, 2, v14
    v_and_b32 v15, 3, v12
    v_add_u32 v14, v14, v15
    v_mul_u32_u24 v14, 2752, v14
    v_lshl_add_u32 v14, v13, 4, v14
    v_add_u32 v24, s13, v14
    v_cmp_le_u32 vcc, s26, v13
    v_mov_b32 v14, 0x40000000
    s_nop 0
    v_cndmask_b32 v24, v24, v14, vcc
    s_add_u32 s8, s14, 64
    v_add_u32 v28, s8, v0
    v_mul_u32_u24 v12, 2731, v28
    v_lshrrev_b32 v12, 16, v12
    v_mul_u32_u24 v13, 24, v12
    v_sub_u32 v13, v28, v13
    v_bfe_u32 v14, v12, 1, 2
    v_lshlrev_b32 v14, 1, v14
    v_xor_b32 v13, v13, v14
    v_bfe_u32 v14, v12, 2, 2
    v_lshlrev_b32 v14, 3, v14
    v_lshrrev_b32 v15, 4, v12
    v_lshl_add_u32 v14, v15, 2, v14
    v_and_b32 v15, 3, v12
    v_add_u32 v14, v14, v15
    v_mul_u32_u24 v14, 2752, v14
    v_lshl_add_u32 v14, v13, 4, v14
    v_add_u32 v25, s13, v14
    v_cmp_le_u32 vcc, s26, v13
    v_mov_b32 v14, 0x40000000
    s_nop 0
    v_cndmask_b32 v25, v25, v14, vcc
    s_add_u32 s8, s14, 128
    v_add_u32 v28, s8, v0
    v_mul_u32_u24 v12, 2731, v28
    v_lshrrev_b32 v12, 16, v12
    v_mul_u32_u24 v13, 24, v12
    v_sub_u32 v13, v28, v13
    v_bfe_u32 v14, v12, 1, 2
    v_lshlrev_b32 v14, 1, v14
    v_xor_b32 v13, v13, v14
    v_bfe_u32 v14, v12, 2, 2
    v_lshlrev_b32 v14, 3, v14
    v_lshrrev_b32 v15, 4, v12
    v_lshl_add_u32 v14, v15, 2, v14
    v_and_b32 v15, 3, v12
    v_add_u32 v14, v14, v15
    v_mul_u32_u24 v14, 2752, v14
    v_lshl_add_u32 v14, v13, 4, v14
    v_add_u32 v26, s13, v14
    v_cmp_le_u32 vcc, s26, v13
    v_mov_b32 v14, 0x40000000
    s_nop 0
    v_cndmask_b32 v26, v26, v14, vcc
    s_mul_i32 s22, s12, 3072
    s_add_u32 s22, s22, 65536
    s_add_u32 s66, s76, 0
    s_add_u32 m0, s22, 0
    s_nop 0
    buffer_load_dwordx4 v24, s[48:51], s66 offen lds
    s_add_u32 m0, s22, 1024
    s_nop 0
    buffer_load_dwordx4 v25, s[48:51], s66 offen lds
    s_add_u32 m0, s22, 2048
    s_nop 0
    buffer_load_dwordx4 v26, s[48:51], s66 offen lds
    s_barrier
    s_add_u32 m0, s10, 16384
    s_nop 0
    buffer_load_dwordx4 v16, s[44:47], s73 offen lds
    s_add_u32 m0, s10, 17408
    s_nop 0
    buffer_load_dwordx4 v17, s[44:47], s73 offen lds
    s_add_u32 m0, s10, 18432
    s_nop 0
    buffer_load_dwordx4 v18, s[44:47], s73 offen lds
    s_add_u32 m0, s10, 19456
    s_nop 0
    buffer_load_dwordx4 v19, s[44:47], s73 offen lds
    s_add_u32 s66, s76, 88064
    s_add_u32 m0, s22, 12288
    s_nop 0
    buffer_load_dwordx4 v24, s[48:51], s66 offen lds
    s_add_u32 m0, s22, 13312
    s_nop 0
    buffer_load_dwordx4 v25, s[48:51], s66 offen lds
    s_add_u32 m0, s22, 14336
    s_nop 0
    buffer_load_dwordx4 v26, s[48:51], s66 offen lds
    s_add_u32 m0, s10, 32768
    s_nop 0
    buffer_load_dwordx4 v16, s[44:47], s74 offen lds
    s_add_u32 m0, s10, 33792
    s_nop 0
    buffer_load_dwordx4 v17, s[44:47], s74 offen lds
    s_add_u32 m0, s10, 34816
    s_nop 0
    buffer_load_dwordx4 v18, s[44:47], s74 offen lds
    s_add_u32 m0, s10, 35840
    s_nop 0
    buffer_load_dwordx4 v19, s[44:47], s74 offen lds
    s_add_u32 s66, s76, 176128
    s_add_u32 m0, s22, 24576
    s_nop 0
    buffer_load_dwordx4 v24, s[48:51], s66 offen lds
    s_add_u32 m0, s22, 25600
    s_nop 0
    buffer_load_dwordx4 v25, s[48:51], s66 offen lds
    s_add_u32 m0, s22, 26624
    s_nop 0
    buffer_load_dwordx4 v26, s[48:51], s66 offen lds
    s_mov_b32 s56, s40
    s_mov_b32 s57, s41
    s_mov_b32 s58, 0x10000000
    s_mov_b32 s59, 0x00020000
    v_mov_b32 v108, 0x3f803f80
    v_mov_b32 v109, 0x3f803f80
    v_mov_b32 v110, 0x3f803f80
    v_mov_b32 v111, 0x3f803f80
    s_mov_b32 s18, 0xaaaaaaaa
    s_mov_b32 s19, 0xaaaaaaaa
    s_mov_b32 s20, 0xcccccccc
    s_mov_b32 s21, 0xcccccccc
    s_mov_b32 s28, 0
    s_lshl_b32 s9, s12, 7
    s_add_u32 s9, s9, 159744
    v_lshl_add_u32 v104, v9, 3, s9
    s_mov_b32 s52, s36
    s_mov_b32 s53, s37
    s_mov_b32 s54, 0x158000
    s_mov_b32 s55, 0x00020000
    s_mul_i32 s71, s12, 22
    s_lshl_b32 s70, s71, 14
    s_lshl_b32 s9, s68, 7
    s_add_u32 s70, s70, s9
    s_mul_i32 s64, s12, 4096
    s_mul_i32 s65, s12, 10240
    s_add_u32 s65, s65, 108544
    v_lshrrev_b32 v12, 3, v0
    v_and_b32 v14, 7, v0
    v_bfe_u32 v15, v0, 4, 1
    v_lshlrev_b32 v15, 2, v15
    v_xor_b32 v14, v14, v15
    v_lshlrev_b32 v12, 10, v12
    v_lshl_add_u32 v112, v14, 4, v12
    v_add_u32 v113, 8192, v112
    s_mov_b32 s25, s70
    v_lshrrev_b32 v12, 2, v9
    v_lshl_add_u32 v12, v10, 3, v12
    s_and_b32 s8, s81, 1
    s_lshl_b32 s8, s8, 3
    s_lshl_b32 s9, s12, 1
    s_add_u32 s8, s8, s9
    v_bfe_u32 v13, v9, 1, 1
    v_add_u32 v13, s8, v13
    s_lshr_b32 s9, s81, 1
    s_sub_u32 s9, s9, s80
    s_and_b32 s9, s9, 3
    s_lshl_b32 s9, s9, 14
    v_and_b32 v14, 1, v9
    v_lshl_add_u32 v14, v14, 3, s9
    v_and_b32 v15, 15, v12
    v_xor_b32 v15, v15, v13
    v_lshl_add_u32 v15, v15, 4, v14
    v_lshl_add_u32 v114, v12, 8, v15
    v_add_u32 v12, 4, v12
    v_and_b32 v15, 15, v12
    v_xor_b32 v15, v15, v13
    v_lshl_add_u32 v15, v15, 4, v14
    v_lshl_add_u32 v115, v12, 8, v15
    v_lshlrev_b32 v105, 6, v10
    v_add_u32 v105, 159744, v105
    s_lshl_b32 s29, s81, 18
    s_lshl_b32 s9, s12, 16
    s_add_u32 s29, s29, s9
    s_lshl_b32 s9, s67, 7
    s_add_u32 s30, s29, s9
    s_add_u32 s30, s30, 16777216
    s_add_u32 s31, s30, 0x8000
    s_lshl_b32 s9, s4, 7
    s_add_u32 s29, s29, s9
    s_add_u32 s29, s29, 8388608
    v_lshlrev_b32 v106, 12, v9
    v_lshl_add_u32 v106, v10, 4, v106
    v_lshrrev_b32 v12, 3, v0
    v_and_b32 v13, 7, v0
    v_lshlrev_b32 v12, 12, v12
    v_lshl_add_u32 v107, v13, 4, v12
    s_lshl_b32 s23, s81, 7
    s_lshl_b32 s9, s4, 2
    s_add_u32 s23, s23, s9
    s_add_u32 s23, s23, 15732736
    v_mov_b32 v128, -1
    v_mov_b32 v129, -1
    v_mov_b32 v130, -1
    v_mov_b32 v131, -1
    v_mov_b32 v12, 1
    s_waitcnt vmcnt(14)
    ds_write_b32 v7, v12 offset:0
    ds_read_b128 v[32:35], v20 offset:0
    ds_read_b128 v[36:39], v21 offset:0
    ds_read_b128 v[40:43], v22 offset:0
    ds_read_b128 v[44:47], v23 offset:0
    s_add_u32 m0, s10, 49152
    s_nop 0
    buffer_load_dwordx4 v16, s[44:47], s75 offen lds
    s_add_u32 m0, s10, 50176
    s_nop 0
    buffer_load_dwordx4 v17, s[44:47], s75 offen lds
    s_add_u32 m0, s10, 51200
    s_nop 0
    buffer_load_dwordx4 v18, s[44:47], s75 offen lds
    s_add_u32 m0, s10, 52224
    s_nop 0
    buffer_load_dwordx4 v19, s[44:47], s75 offen lds
    s_add_u32 s66, s76, 264192
    s_add_u32 m0, s22, 36864
    s_nop 0
    buffer_load_dwordx4 v24, s[48:51], s66 offen lds
    s_add_u32 m0, s22, 37888
    s_nop 0
    buffer_load_dwordx4 v25, s[48:51], s66 offen lds
    s_add_u32 m0, s22, 38912
    s_nop 0
    buffer_load_dwordx4 v26, s[48:51], s66 offen lds
    s_waitcnt lgkmcnt(0)
    v_mfma_f32_16x16x32_bf16 v[96:99], v[108:111], v[32:35], 0
    v_mfma_f32_16x16x32_bf16 v[100:103], v[32:35], v[32:35], 0
    v_mfma_f32_16x16x32_bf16 v[96:99], v[108:111], v[36:39], v[96:99]
    v_mfma_f32_16x16x32_bf16 v[100:103], v[36:39], v[36:39], v[100:103]
    v_mfma_f32_16x16x32_bf16 v[96:99], v[108:111], v[40:43], v[96:99]
    v_mfma_f32_16x16x32_bf16 v[100:103], v[40:43], v[40:43], v[100:103]
    v_mfma_f32_16x16x32_bf16 v[96:99], v[108:111], v[44:47], v[96:99]
    v_mfma_f32_16x16x32_bf16 v[100:103], v[44:47], v[44:47], v[100:103]
    v_mov_b32 v12, 2
    s_waitcnt vmcnt(14)
    ds_write_b32 v7, v12 offset:0
    ds_read_b128 v[48:51], v20 offset:16384
    ds_read_b128 v[52:55], v21 offset:16384
    ds_read_b128 v[56:59], v22 offset:16384
    ds_read_b128 v[60:63], v23 offset:16384
    s_add_u32 s66, s77, 0
    s_add_u32 m0, s22, 49152
    s_nop 0
    buffer_load_dwordx4 v24, s[48:51], s66 offen lds
    s_add_u32 m0, s22, 50176
    s_nop 0
    buffer_load_dwordx4 v25, s[48:51], s66 offen lds
    s_add_u32 m0, s22, 51200
    s_nop 0
    buffer_load_dwordx4 v26, s[48:51], s66 offen lds
    s_lshl_b32 s8, s2, 2
    s_add_u32 s8, s8, s12
    s_mul_i32 s8, s8, 1376
    v_min_u32 v12, 352, v11
    buffer_load_dwordx4 v[160:163], v11, s[52:55], s8 offen
    buffer_load_dwordx4 v[164:167], v12, s[52:55], s8 offen offset:1024
    s_waitcnt lgkmcnt(0)
    v_mfma_f32_16x16x32_bf16 v[96:99], v[108:111], v[48:51], v[96:99]
    v_mfma_f32_16x16x32_bf16 v[100:103], v[48:51], v[48:51], v[100:103]
    v_mfma_f32_16x16x32_bf16 v[96:99], v[108:111], v[52:55], v[96:99]
    v_mfma_f32_16x16x32_bf16 v[100:103], v[52:55], v[52:55], v[100:103]
    v_mfma_f32_16x16x32_bf16 v[96:99], v[108:111], v[56:59], v[96:99]
    v_mfma_f32_16x16x32_bf16 v[100:103], v[56:59], v[56:59], v[100:103]
    v_mfma_f32_16x16x32_bf16 v[96:99], v[108:111], v[60:63], v[96:99]
    v_mfma_f32_16x16x32_bf16 v[100:103], v[60:63], v[60:63], v[100:103]
    v_mov_b32 v12, 3
    s_waitcnt vmcnt(12)
    ds_write_b32 v7, v12 offset:0
    ds_read_b128 v[64:67], v20 offset:32768
    ds_read_b128 v[68:71], v21 offset:32768
    ds_read_b128 v[72:75], v22 offset:32768
    ds_read_b128 v[76:79], v23 offset:32768
    s_add_u32 s66, s77, 88064
    s_add_u32 m0, s22, 61440
    s_nop 0
    buffer_load_dwordx4 v24, s[48:51], s66 offen lds
    s_add_u32 m0, s22, 62464
    s_nop 0
    buffer_load_dwordx4 v25, s[48:51], s66 offen lds
    s_add_u32 m0, s22, 63488
    s_nop 0
    buffer_load_dwordx4 v26, s[48:51], s66 offen lds
    s_waitcnt lgkmcnt(0)
    v_mfma_f32_16x16x32_bf16 v[96:99], v[108:111], v[64:67], v[96:99]
    v_mfma_f32_16x16x32_bf16 v[100:103], v[64:67], v[64:67], v[100:103]
    v_mfma_f32_16x16x32_bf16 v[96:99], v[108:111], v[68:71], v[96:99]
    v_mfma_f32_16x16x32_bf16 v[100:103], v[68:71], v[68:71], v[100:103]
    v_mfma_f32_16x16x32_bf16 v[96:99], v[108:111], v[72:75], v[96:99]
    v_mfma_f32_16x16x32_bf16 v[100:103], v[72:75], v[72:75], v[100:103]
    v_mfma_f32_16x16x32_bf16 v[96:99], v[108:111], v[76:79], v[96:99]
    v_mfma_f32_16x16x32_bf16 v[100:103], v[76:79], v[76:79], v[100:103]
    v_mov_b32 v12, 4
    s_waitcnt vmcnt(8)
    ds_write_b32 v7, v12 offset:0
    ds_read_b128 v[80:83], v20 offset:49152
    ds_read_b128 v[84:87], v21 offset:49152
    ds_read_b128 v[88:91], v22 offset:49152
    ds_read_b128 v[92:95], v23 offset:49152
    s_add_u32 s66, s77, 176128
    s_add_u32 m0, s22, 73728
    s_nop 0
    buffer_load_dwordx4 v24, s[48:51], s66 offen lds
    s_add_u32 m0, s22, 74752
    s_nop 0
    buffer_load_dwordx4 v25, s[48:51], s66 offen lds
    s_add_u32 m0, s22, 75776
    s_nop 0
    buffer_load_dwordx4 v26, s[48:51], s66 offen lds
    s_waitcnt lgkmcnt(0)
    v_mfma_f32_16x16x32_bf16 v[96:99], v[108:111], v[80:83], v[96:99]
    v_mfma_f32_16x16x32_bf16 v[100:103], v[80:83], v[80:83], v[100:103]
    v_mfma_f32_16x16x32_bf16 v[96:99], v[108:111], v[84:87], v[96:99]
    v_mfma_f32_16x16x32_bf16 v[100:103], v[84:87], v[84:87], v[100:103]
    v_mfma_f32_16x16x32_bf16 v[96:99], v[108:111], v[88:91], v[96:99]
    v_mfma_f32_16x16x32_bf16 v[100:103], v[88:91], v[88:91], v[100:103]
    v_mfma_f32_16x16x32_bf16 v[96:99], v[108:111], v[92:95], v[96:99]
    v_mfma_f32_16x16x32_bf16 v[100:103], v[92:95], v[92:95], v[100:103]
    s_nop 7
    v_cndmask_b32 v100, v100, v101, s[18:19]
    v_cndmask_b32 v102, v102, v103, s[18:19]
    v_mul_f32 v96, 0x3b000000, v96
    v_cndmask_b32 v100, v100, v102, s[20:21]
    v_mul_f32 v100, 0x3b000000, v100
    v_fma_f32 v100, -v96, v96, v100
    v_max_f32 v100, 0, v100
    v_cvt_pk_bf16_f32 v97, v96, v100
    v_lshlrev_b32 v96, 16, v97
    v_and_b32 v100, 0xffff0000, v97
    v_add_f32 v100, 0x3727c5ac, v100
    v_cvt_pk_bf16_f32 v100, v100, v100
    v_lshlrev_b32 v100, 16, v100
    v_sqrt_f32 v100, v100
    s_nop 0
    v_cvt_pk_bf16_f32 v100, v100, v100
    v_lshlrev_b32 v100, 16, v100
    v_rcp_f32 v100, v100
    s_nop 0
    v_mul_f32 v101, -v96, v100
    s_mov_b32 exec_lo, 0x00f0000f
    s_mov_b32 exec_hi, 0xf0000f00
    ds_write_b64 v104, v[100:101]
    s_mov_b64 exec, -1
    ds_write_b32 v7, v6 offset:16
    v_mov_b32 v12, 5
    s_waitcnt vmcnt(8)
    ds_write_b32 v7, v12 offset:0
    s_cmp_lt_u32 s28, 1
    s_cbranch_scc1 LSLOW_56
LBACK_57:
    s_add_u32 s66, s77, 264192
    s_add_u32 m0, s22, 0
    s_nop 0
    buffer_load_dwordx4 v24, s[48:51], s66 offen lds
    s_add_u32 m0, s22, 1024
    s_nop 0
    buffer_load_dwordx4 v25, s[48:51], s66 offen lds
    s_add_u32 m0, s22, 2048
    s_nop 0
    buffer_load_dwordx4 v26, s[48:51], s66 offen lds
SPIN_58:
    ds_read_b128 v[116:119], v8 offset:16
    s_waitcnt lgkmcnt(0)
    v_min3_u32 v116, v116, v117, v118
    v_min_u32 v116, v116, v119
    s_nop 0
    v_readfirstlane_b32 s9, v116
    s_nop 0
    s_cmp_lt_u32 s9, 1
    s_cbranch_scc1 SPIN_58
    ds_read_b64_tr_b16 v[120:121], v114 offset:0
    ds_read_b64_tr_b16 v[124:125], v114 offset:8192
    ds_read_b64_tr_b16 v[122:123], v115 offset:0
    ds_read_b64_tr_b16 v[126:127], v115 offset:8192
    ds_write_b32 v7, v6 offset:80
    ds_read_b128 v[32:35], v105 offset:0
    ds_read_b128 v[36:39], v105 offset:16
    ds_read_b128 v[40:43], v105 offset:32
    ds_read_b128 v[44:47], v105 offset:48
    ds_read_b128 v[48:51], v105 offset:256
    ds_read_b128 v[52:55], v105 offset:272
    ds_read_b128 v[56:59], v105 offset:288
    ds_read_b128 v[60:63], v105 offset:304
    v_mov_b32 v12, 6
    s_waitcnt vmcnt(6)
    ds_write_b32 v7, v12 offset:0
    s_cmp_lt_u32 s28, 2
    s_cbranch_scc1 LSLOW_59
LBACK_60:
    s_add_u32 s66, s78, 0
    s_add_u32 m0, s22, 12288
    s_nop 0
    buffer_load_dwordx4 v24, s[48:51], s66 offen lds
    s_add_u32 m0, s22, 13312
    s_nop 0
    buffer_load_dwordx4 v25, s[48:51], s66 offen lds
    s_add_u32 m0, s22, 14336
    s_nop 0
    buffer_load_dwordx4 v26, s[48:51], s66 offen lds
    s_waitcnt lgkmcnt(0)
    v_lshlrev_b32 v64, 16, v120
    v_and_b32 v65, 0xffff0000, v120
    v_lshlrev_b32 v66, 16, v121
    v_and_b32 v67, 0xffff0000, v121
    v_lshlrev_b32 v68, 16, v122
    v_and_b32 v69, 0xffff0000, v122
    v_lshlrev_b32 v70, 16, v123
    v_and_b32 v71, 0xffff0000, v123
    v_lshlrev_b32 v72, 16, v124
    v_and_b32 v73, 0xffff0000, v124
    v_lshlrev_b32 v74, 16, v125
    v_and_b32 v75, 0xffff0000, v125
    v_lshlrev_b32 v76, 16, v126
    v_and_b32 v77, 0xffff0000, v126
    v_lshlrev_b32 v78, 16, v127
    v_and_b32 v79, 0xffff0000, v127
    v_fma_f32 v64, v64, v32, v33
    v_fma_f32 v65, v65, v34, v35
    v_fma_f32 v66, v66, v36, v37
    v_fma_f32 v67, v67, v38, v39
    v_fma_f32 v68, v68, v40, v41
    v_fma_f32 v69, v69, v42, v43
    v_fma_f32 v70, v70, v44, v45
    v_fma_f32 v71, v71, v46, v47
    v_fma_f32 v72, v72, v48, v49
    v_fma_f32 v73, v73, v50, v51
    v_fma_f32 v74, v74, v52, v53
    v_fma_f32 v75, v75, v54, v55
    v_fma_f32 v76, v76, v56, v57
    v_fma_f32 v77, v77, v58, v59
    v_fma_f32 v78, v78, v60, v61
    v_fma_f32 v79, v79, v62, v63
    v_cvt_pk_f16_f32 v120, v64, v65
    v_cvt_pk_f16_f32 v121, v66, v67
    v_cvt_pk_f16_f32 v122, v68, v69
    v_cvt_pk_f16_f32 v123, v70, v71
    v_cvt_pk_f16_f32 v124, v72, v73
    v_cvt_pk_f16_f32 v125, v74, v75
    v_cvt_pk_f16_f32 v126, v76, v77
    v_cvt_pk_f16_f32 v127, v78, v79
    s_cmp_lt_u32 s28, 3
    s_cbranch_scc1 LSLOW_61
LBACK_62:
    s_add_u32 s66, s78, 88064
    s_add_u32 m0, s22, 24576
    s_nop 0
    buffer_load_dwordx4 v24, s[48:51], s66 offen lds
    s_add_u32 m0, s22, 25600
    s_nop 0
    buffer_load_dwordx4 v25, s[48:51], s66 offen lds
    s_add_u32 m0, s22, 26624
    s_nop 0
    buffer_load_dwordx4 v26, s[48:51], s66 offen lds
    buffer_store_dwordx4 v[120:123], v106, s[56:59], s29 offen sc1
    buffer_store_dwordx4 v[124:127], v106, s[56:59], s29 offen offset:64 sc1
    buffer_store_dwordx4 v[128:131], v107, s[56:59], s30 offen sc1
    buffer_store_dwordx4 v[128:131], v107, s[56:59], s31 offen sc1
    v_mov_b32 v12, 7
    s_waitcnt vmcnt(13)
    ds_write_b32 v7, v12 offset:0
    s_cmp_lt_u32 s28, 4
    s_cbranch_scc1 LSLOW_63
LBACK_64:
    s_add_u32 s66, s78, 176128
    s_add_u32 m0, s22, 36864
    s_nop 0
    buffer_load_dwordx4 v24, s[48:51], s66 offen lds
    s_add_u32 m0, s22, 37888
    s_nop 0
    buffer_load_dwordx4 v25, s[48:51], s66 offen lds
    s_add_u32 m0, s22, 38912
    s_nop 0
    buffer_load_dwordx4 v26, s[48:51], s66 offen lds
    v_mov_b32 v12, 8
    s_waitcnt vmcnt(13)
    ds_write_b32 v7, v12 offset:0
    s_cmp_lt_u32 s28, 5
    s_cbranch_scc1 LSLOW_65
LBACK_66:
    s_add_u32 s66, s78, 264192
    s_add_u32 m0, s22, 49152
    s_nop 0
    buffer_load_dwordx4 v24, s[48:51], s66 offen lds
    s_add_u32 m0, s22, 50176
    s_nop 0
    buffer_load_dwordx4 v25, s[48:51], s66 offen lds
    s_add_u32 m0, s22, 51200
    s_nop 0
    buffer_load_dwordx4 v26, s[48:51], s66 offen lds
    v_mov_b32 v12, 9
    s_waitcnt vmcnt(13)
    ds_write_b32 v7, v12 offset:0
    s_cmp_lt_u32 s28, 6
    s_cbranch_scc1 LSLOW_67
LBACK_68:
    s_add_u32 s66, s79, 0
    s_add_u32 m0, s22, 61440
    s_nop 0
    buffer_load_dwordx4 v24, s[48:51], s66 offen lds
    s_add_u32 m0, s22, 62464
    s_nop 0
    buffer_load_dwordx4 v25, s[48:51], s66 offen lds
    s_add_u32 m0, s22, 63488
    s_nop 0
    buffer_load_dwordx4 v26, s[48:51], s66 offen lds
    v_mov_b32 v12, 10
    s_waitcnt vmcnt(13)
    ds_write_b32 v7, v12 offset:0
    s_waitcnt vmcnt(0)
    v_mov_b32 v12, 13
    ds_write_b32 v7, v12 offset:0
    s_mov_b64 exec, 1
    ds_add_rtn_u32 v116, v8, v6 offset:164
    v_mov_b32 v117, 0
    s_waitcnt lgkmcnt(0)
    v_readfirstlane_b32 s82, v116
    s_nop 0
    s_cmp_lg_u32 s82, 3
    s_cbranch_scc1 KF_PUBU
SPIN_69:
    ds_read_b32 v116, v8 offset:172
    s_waitcnt lgkmcnt(0)
    v_readfirstlane_b32 s82, v116
    s_nop 0
    s_cmp_eq_u32 s82, 0
    s_cbranch_scc1 SPIN_69
    buffer_store_dword v6, v117, s[56:59], s23 offen sc1
KF_PUBU:
    s_mov_b64 exec, -1
    s_cmp_lt_u32 s28, 7
    s_cbranch_scc1 LSLOW_70
LBACK_71:
    s_add_u32 s66, s79, 88064
    s_add_u32 m0, s22, 73728
    s_nop 0
    buffer_load_dwordx4 v24, s[48:51], s66 offen lds
    s_add_u32 m0, s22, 74752
    s_nop 0
    buffer_load_dwordx4 v25, s[48:51], s66 offen lds
    s_add_u32 m0, s22, 75776
    s_nop 0
    buffer_load_dwordx4 v26, s[48:51], s66 offen lds
    s_cmp_lt_u32 s28, 8
    s_cbranch_scc1 LSLOW_72
LBACK_73:
    s_add_u32 s66, s79, 176128
    s_add_u32 m0, s22, 0
    s_nop 0
    buffer_load_dwordx4 v24, s[48:51], s66 offen lds
    s_add_u32 m0, s22, 1024
    s_nop 0
    buffer_load_dwordx4 v25, s[48:51], s66 offen lds
    s_add_u32 m0, s22, 2048
    s_nop 0
    buffer_load_dwordx4 v26, s[48:51], s66 offen lds
    s_cmp_lt_u32 s28, 9
    s_cbranch_scc1 LSLOW_74
LBACK_75:
    s_add_u32 s66, s79, 264192
    s_add_u32 m0, s22, 12288
    s_nop 0
    buffer_load_dwordx4 v24, s[48:51], s66 offen lds
    s_add_u32 m0, s22, 13312
    s_nop 0
    buffer_load_dwordx4 v25, s[48:51], s66 offen lds
    s_add_u32 m0, s22, 14336
    s_nop 0
    buffer_load_dwordx4 v26, s[48:51], s66 offen lds
    s_add_u32 s24, s25, 180224
    buffer_load_dwordx4 v[128:131], v112, s[52:55], s24 offen
    buffer_load_dwordx4 v[132:135], v113, s[52:55], s24 offen
    s_add_u32 s24, s24, 16384
    buffer_load_dwordx4 v[136:139], v112, s[52:55], s24 offen
    buffer_load_dwordx4 v[140:143], v113, s[52:55], s24 offen
    s_add_u32 s24, s24, 16384
    v_mov_b32 v12, 14
    s_waitcnt vmcnt(10)
    ds_write_b32 v7, v12 offset:0
    buffer_load_dwordx4 v[144:147], v112, s[52:55], s24 offen
    buffer_load_dwordx4 v[148:151], v113, s[52:55], s24 offen
    s_add_u32 s24, s24, 16384
    buffer_load_dwordx4 v[152:155], v112, s[52:55], s24 offen
    buffer_load_dwordx4 v[156:159], v113, s[52:55], s24 offen
    s_add_u32 s24, s24, 16384
    v_mov_b32 v12, 15
    s_waitcnt vmcnt(11)
    ds_write_b32 v7, v12 offset:0
    v_mov_b32 v12, 16
    s_waitcnt vmcnt(8)
    ds_write_b32 v7, v12 offset:0
SPIN_76:
    ds_read_b128 v[20:23], v8 offset:80
    s_waitcnt lgkmcnt(0)
    v_min3_u32 v20, v20, v21, v22
    v_min_u32 v20, v20, v23
    s_nop 0
    v_readfirstlane_b32 s8, v20
    s_nop 0
    s_cmp_lt_u32 s8, 1
    s_cbranch_scc1 SPIN_76
    s_setprio 0
    s_add_u32 m0, s64, 0
    s_nop 0
    buffer_load_dwordx4 v112, s[52:55], s70 offen lds
    s_add_u32 m0, s64, 1024
    s_nop 0
    buffer_load_dwordx4 v113, s[52:55], s70 offen lds
    s_add_u32 s70, s70, 16384
    s_add_u32 m0, s64, 2048
    s_nop 0
    buffer_load_dwordx4 v112, s[52:55], s70 offen lds
    s_add_u32 m0, s64, 3072
    s_nop 0
    buffer_load_dwordx4 v113, s[52:55], s70 offen lds
    s_add_u32 s70, s70, 16384
    s_add_u32 m0, s64, 16384
    s_nop 0
    buffer_load_dwordx4 v112, s[52:55], s70 offen lds
    s_add_u32 m0, s64, 17408
    s_nop 0
    buffer_load_dwordx4 v113, s[52:55], s70 offen lds
    s_add_u32 s70, s70, 16384
    s_add_u32 m0, s64, 18432
    s_nop 0
    buffer_load_dwordx4 v112, s[52:55], s70 offen lds
    s_add_u32 m0, s64, 19456
    s_nop 0
    buffer_load_dwordx4 v113, s[52:55], s70 offen lds
    s_add_u32 s70, s70, 16384
SPIN_77:
    s_sleep 1
    ds_read_b128 v[20:23], v8 offset:48
    s_waitcnt lgkmcnt(0)
    v_min3_u32 v20, v20, v21, v22
    v_min_u32 v20, v20, v23
    s_nop 0
    v_readfirstlane_b32 s8, v20
    s_nop 0
    s_cmp_lt_u32 s8, 12
    s_cbranch_scc1 SPIN_77
    s_add_u32 m0, s64, 32768
    s_nop 0
    buffer_load_dwordx4 v112, s[52:55], s70 offen lds
    s_add_u32 m0, s64, 33792
    s_nop 0
    buffer_load_dwordx4 v113, s[52:55], s70 offen lds
    s_add_u32 s70, s70, 16384
    s_add_u32 m0, s64, 34816
    s_nop 0
    buffer_load_dwordx4 v112, s[52:55], s70 offen lds
    s_add_u32 m0, s64, 35840
    s_nop 0
    buffer_load_dwordx4 v113, s[52:55], s70 offen lds
    s_add_u32 s70, s70, 16384
    s_waitcnt vmcnt(0)
    ds_write_b32 v7, v6 offset:128
SPIN_78:
    s_sleep 1
    ds_read_b128 v[20:23], v8 offset:144
    s_waitcnt lgkmcnt(0)
    v_min3_u32 v20, v20, v21, v22
    v_min_u32 v20, v20, v23
    s_nop 0
    v_readfirstlane_b32 s8, v20
    s_nop 0
    s_cmp_lt_u32 s8, 1
    s_cbranch_scc1 SPIN_78
    s_add_u32 m0, s65, 0
    s_nop 0
    buffer_load_dwordx4 v112, s[52:55], s70 offen lds
    s_add_u32 m0, s65, 1024
    s_nop 0
    buffer_load_dwordx4 v113, s[52:55], s70 offen lds
    s_add_u32 s70, s70, 16384
    s_add_u32 m0, s65, 2048
    s_nop 0
    buffer_load_dwordx4 v112, s[52:55], s70 offen lds
    s_add_u32 m0, s65, 3072
    s_nop 0
    buffer_load_dwordx4 v113, s[52:55], s70 offen lds
    s_add_u32 s70, s70, 16384
    s_add_u32 m0, s65, 4096
    s_nop 0
    buffer_load_dwordx4 v112, s[52:55], s70 offen lds
    s_add_u32 m0, s65, 5120
    s_nop 0
    buffer_load_dwordx4 v113, s[52:55], s70 offen lds
    s_add_u32 s70, s70, 16384
    s_add_u32 m0, s65, 6144
    s_nop 0
    buffer_load_dwordx4 v112, s[52:55], s70 offen lds
    s_add_u32 m0, s65, 7168
    s_nop 0
    buffer_load_dwordx4 v113, s[52:55], s70 offen lds
    s_add_u32 s70, s70, 16384
    s_add_u32 m0, s65, 8192
    s_nop 0
    buffer_load_dwordx4 v112, s[52:55], s70 offen lds
    s_add_u32 m0, s65, 9216
    s_nop 0
    buffer_load_dwordx4 v113, s[52:55], s70 offen lds
    s_add_u32 s70, s70, 16384
    buffer_load_dwordx4 v[160:163], v112, s[52:55], s24 offen
    buffer_load_dwordx4 v[164:167], v113, s[52:55], s24 offen
    s_add_u32 s24, s24, 16384
    buffer_load_dwordx4 v[32:35], v112, s[52:55], s24 offen
    buffer_load_dwordx4 v[36:39], v113, s[52:55], s24 offen
    s_add_u32 s24, s24, 16384
    buffer_load_dwordx4 v[40:43], v112, s[52:55], s24 offen
    buffer_load_dwordx4 v[44:47], v113, s[52:55], s24 offen
    s_add_u32 s24, s24, 16384
    buffer_load_dwordx4 v[48:51], v112, s[52:55], s24 offen
    buffer_load_dwordx4 v[52:55], v113, s[52:55], s24 offen
    s_add_u32 s24, s24, 16384
    s_waitcnt vmcnt(8)
    ds_write_b32 v7, v6 offset:224
    buffer_load_dwordx4 v[56:59], v112, s[52:55], s24 offen
    buffer_load_dwordx4 v[60:63], v113, s[52:55], s24 offen
    s_add_u32 s24, s24, 16384
    buffer_load_dwordx4 v[64:67], v112, s[52:55], s24 offen
    buffer_load_dwordx4 v[68:71], v113, s[52:55], s24 offen
    s_add_u32 s24, s24, 16384
    buffer_load_dwordx4 v[72:75], v112, s[52:55], s24 offen
    buffer_load_dwordx4 v[76:79], v113, s[52:55], s24 offen
    s_add_u32 s24, s24, 16384
    v_add_u32 v16, s64, v11
    v_add_u32 v17, s65, v11
LW_79:
    s_sleep 1
    ds_read_b32 v20, v7 offset:208
    s_waitcnt lgkmcnt(0)
    v_readfirstlane_b32 s8, v20
    s_nop 0
    s_cmp_lt_u32 s8, 1
    s_cbranch_scc1 LW_79
    s_waitcnt vmcnt(14)
    ds_write_b128 v16, v[128:131] offset:0
    ds_write_b128 v16, v[132:135] offset:1024
    ds_write_b128 v16, v[136:139] offset:2048
    ds_write_b128 v16, v[140:143] offset:3072
    ds_write_b128 v16, v[144:147] offset:16384
    ds_write_b128 v16, v[148:151] offset:17408
    ds_write_b128 v16, v[152:155] offset:18432
    ds_write_b128 v16, v[156:159] offset:19456
    v_mov_b32 v20, 2
    ds_write_b32 v7, v20 offset:224
LW_80:
    s_sleep 1
    ds_read_b32 v20, v7 offset:208
    s_waitcnt lgkmcnt(0)
    v_readfirstlane_b32 s8, v20
    s_nop 0
    s_cmp_lt_u32 s8, 2
    s_cbranch_scc1 LW_80
    s_waitcnt vmcnt(6)
    ds_write_b128 v16, v[160:163] offset:32768
    ds_write_b128 v16, v[164:167] offset:33792
    ds_write_b128 v16, v[32:35] offset:34816
    ds_write_b128 v16, v[36:39] offset:35840
    ds_write_b128 v17, v[40:43] offset:0
    ds_write_b128 v17, v[44:47] offset:1024
    ds_write_b128 v17, v[48:51] offset:2048
    ds_write_b128 v17, v[52:55] offset:3072
    v_mov_b32 v20, 3
    ds_write_b32 v7, v20 offset:224
LW_81:
    s_sleep 1
    ds_read_b32 v20, v7 offset:208
    s_waitcnt lgkmcnt(0)
    v_readfirstlane_b32 s8, v20
    s_nop 0
    s_cmp_lt_u32 s8, 3
    s_cbranch_scc1 LW_81
    s_waitcnt vmcnt(0)
    ds_write_b128 v17, v[56:59] offset:4096
    ds_write_b128 v17, v[60:63] offset:5120
    ds_write_b128 v17, v[64:67] offset:6144
    ds_write_b128 v17, v[68:71] offset:7168
    ds_write_b128 v17, v[72:75] offset:8192
    ds_write_b128 v17, v[76:79] offset:9216
    v_mov_b32 v20, 4
    ds_write_b32 v7, v20 offset:224
    s_branch KF_FIN
LSLOW_56:
SPIN_82:
    ds_read_b128 v[28:31], v8 offset:48
    s_waitcnt lgkmcnt(0)
    v_min3_u32 v28, v28, v29, v30
    v_min_u32 v28, v28, v31
    s_nop 0
    v_readfirstlane_b32 s28, v28
    s_nop 0
    s_cmp_lt_u32 s28, 1
    s_cbranch_scc1 SPIN_82
    s_branch LBACK_57
LSLOW_59:
SPIN_83:
    ds_read_b128 v[28:31], v8 offset:48
    s_waitcnt lgkmcnt(0)
    v_min3_u32 v28, v28, v29, v30
    v_min_u32 v28, v28, v31
    s_nop 0
    v_readfirstlane_b32 s28, v28
    s_nop 0
    s_cmp_lt_u32 s28, 2
    s_cbranch_scc1 SPIN_83
    s_branch LBACK_60
LSLOW_61:
SPIN_84:
    ds_read_b128 v[28:31], v8 offset:48
    s_waitcnt lgkmcnt(0)
    v_min3_u32 v28, v28, v29, v30
    v_min_u32 v28, v28, v31
    s_nop 0
    v_readfirstlane_b32 s28, v28
    s_nop 0
    s_cmp_lt_u32 s28, 3
    s_cbranch_scc1 SPIN_84
    s_branch LBACK_62
LSLOW_63:
SPIN_85:
    ds_read_b128 v[28:31], v8 offset:48
    s_waitcnt lgkmcnt(0)
    v_min3_u32 v28, v28, v29, v30
    v_min_u32 v28, v28, v31
    s_nop 0
    v_readfirstlane_b32 s28, v28
    s_nop 0
    s_cmp_lt_u32 s28, 4
    s_cbranch_scc1 SPIN_85
    s_branch LBACK_64
LSLOW_65:
SPIN_86:
    ds_read_b128 v[28:31], v8 offset:48
    s_waitcnt lgkmcnt(0)
    v_min3_u32 v28, v28, v29, v30
    v_min_u32 v28, v28, v31
    s_nop 0
    v_readfirstlane_b32 s28, v28
    s_nop 0
    s_cmp_lt_u32 s28, 5
    s_cbranch_scc1 SPIN_86
    s_branch LBACK_66
LSLOW_67:
SPIN_87:
    ds_read_b128 v[28:31], v8 offset:48
    s_waitcnt lgkmcnt(0)
    v_min3_u32 v28, v28, v29, v30
    v_min_u32 v28, v28, v31
    s_nop 0
    v_readfirstlane_b32 s28, v28
    s_nop 0
    s_cmp_lt_u32 s28, 6
    s_cbranch_scc1 SPIN_87
    s_branch LBACK_68
LSLOW_70:
SPIN_88:
    ds_read_b128 v[28:31], v8 offset:48
    s_waitcnt lgkmcnt(0)
    v_min3_u32 v28, v28, v29, v30
    v_min_u32 v28, v28, v31
    s_nop 0
    v_readfirstlane_b32 s28, v28
    s_nop 0
    s_cmp_lt_u32 s28, 7
    s_cbranch_scc1 SPIN_88
    s_branch LBACK_71
LSLOW_72:
SPIN_89:
    ds_read_b128 v[28:31], v8 offset:48
    s_waitcnt lgkmcnt(0)
    v_min3_u32 v28, v28, v29, v30
    v_min_u32 v28, v28, v31
    s_nop 0
    v_readfirstlane_b32 s28, v28
    s_nop 0
    s_cmp_lt_u32 s28, 8
    s_cbranch_scc1 SPIN_89
    s_branch LBACK_73
LSLOW_74:
SPIN_90:
    ds_read_b128 v[28:31], v8 offset:48
    s_waitcnt lgkmcnt(0)
    v_min3_u32 v28, v28, v29, v30
    v_min_u32 v28, v28, v31
    s_nop 0
    v_readfirstlane_b32 s28, v28
    s_nop 0
    s_cmp_lt_u32 s28, 9
    s_cbranch_scc1 SPIN_90
    s_branch LBACK_75
KF_A:
    s_lshr_b32 s13, s12, 1
    s_and_b32 s14, s12, 1
    s_lshl_b32 s15, s69, 1
    s_add_u32 s15, s15, s13
    s_lshl_b32 s10, s15, 8
    s_lshl_b32 s8, s14, 7
    s_add_u32 s8, s8, s10
    v_lshl_add_u32 v12, v0, 1, s8
    v_lshl_add_u32 v13, v0, 2, s10
    s_lshl_b32 s10, s69, 2
    s_waitcnt lgkmcnt(0)
    global_load_ushort v152, v12, s[18:19]
    global_load_ushort v153, v12, s[20:21]
    global_load_ushort v154, v12, s[22:23]
    global_load_ushort v155, v12, s[24:25]
    global_load_dword v156, v13, s[22:23]
    global_load_dword v157, v13, s[24:25]
    s_load_dword s66, s[26:27], s10
    s_load_dword s79, s[28:29], s10
    s_getpc_b64 s[44:45]
KF_PC:
    s_sub_u32 s44, s44, KF_PC-KF_START
    s_subb_u32 s45, s45, 0
    s_lshl_b32 s8, s7, 2
    s_add_u32 s8, s8, s12
    s_lshl_b32 s8, s8, 8
    v_lshl_add_u32 v14, v0, 2, s8
    v_min_u32 v14, CODE_END-KF_START-4, v14
    global_load_dword v158, v14, s[44:45]
    s_mov_b32 s56, s40
    s_mov_b32 s57, s41
    s_mov_b32 s58, 0x10000000
    s_mov_b32 s59, 0x00020000
    s_lshl_b32 s78, s69, 2
    s_add_u32 s78, s78, 15733760
    s_lshr_b32 s52, s69, 5
    s_lshl_b32 s52, s52, 7
    s_add_u32 s52, s52, 15732736
    s_lshl_b32 s53, s68, 7
    s_add_u32 s53, s53, 15733760
    v_and_b32 v4, 31, v0
    v_lshlrev_b32 v4, 2, v4
    s_mov_b32 s48, s62
    s_mov_b32 s49, s63
    s_mov_b32 s50, 0x100
    s_mov_b32 s51, 0x00020000
    s_barrier
    s_mul_i32 s64, s12, 2048
    s_add_u32 s64, s64, 151552
    v_lshlrev_b32 v12, 4, v10
    v_add_u32 v132, s64, v12
    v_cvt_f32_u32 v133, v9
    v_mov_b32 v136, 0
    v_mov_b32 v137, 0
    v_mov_b32 v138, 0
    v_mov_b32 v139, 0
    v_mov_b32 v140, 0
    v_mov_b32 v141, 0
    v_mov_b32 v142, 0
    v_mov_b32 v143, 0
    v_mov_b32 v144, 0
    v_mov_b32 v145, 0
    v_mov_b32 v146, 0
    v_mov_b32 v147, 0
    v_mov_b32 v148, 0
    v_mov_b32 v149, 0
    v_mov_b32 v150, 0
    v_mov_b32 v151, 0
    v_mul_u32_u24 v12, 384, v10
    v_lshl_add_u32 v12, v9, 2, v12
    v_add_u32 v12, s64, v12
    s_lshl_b32 s77, s13, 12
    s_add_u32 s77, s77, 152576
    s_lshl_b32 s8, s14, 9
    v_lshl_add_u32 v88, v0, 3, s8
    v_cvt_f32_u32 v88, v88
    v_add_f32 v89, 0xc0400000, v88
    v_add_f32 v90, 0xc0000000, v88
    v_cvt_pk_bf16_f32 v89, v89, v90
    v_and_b32 v90, 0xffff0000, v89
    v_lshlrev_b32 v89, 16, v89
    v_cvt_u32_f32 v89, v89
    v_cvt_u32_f32 v90, v90
    v_lshrrev_b32 v91, 2, v89
    v_add_u32 v91, 384, v91
    v_min_u32 v91, v89, v91
    v_xor_b32 v91, 0x200, v91
    v_lshl_add_u32 v112, v91, 1, s77
    v_lshrrev_b32 v91, 2, v90
    v_add_u32 v91, 384, v91
    v_min_u32 v91, v90, v91
    v_xor_b32 v91, 0x200, v91
    v_lshl_add_u32 v113, v91, 1, s77
    v_add_f32 v89, 0xbf800000, v88
    v_add_f32 v90, 0x00000000, v88
    v_cvt_pk_bf16_f32 v89, v89, v90
    v_and_b32 v90, 0xffff0000, v89
    v_lshlrev_b32 v89, 16, v89
    v_cvt_u32_f32 v89, v89
    v_cvt_u32_f32 v90, v90
    v_lshrrev_b32 v91, 2, v89
    v_add_u32 v91, 384, v91
    v_min_u32 v91, v89, v91
    v_xor_b32 v91, 0x200, v91
    v_lshl_add_u32 v114, v91, 1, s77
    v_lshrrev_b32 v91, 2, v90
    v_add_u32 v91, 384, v91
    v_min_u32 v91, v90, v91
    v_xor_b32 v91, 0x200, v91
    v_lshl_add_u32 v115, v91, 1, s77
    v_add_f32 v89, 0x3f800000, v88
    v_add_f32 v90, 0x40000000, v88
    v_cvt_pk_bf16_f32 v89, v89, v90
    v_and_b32 v90, 0xffff0000, v89
    v_lshlrev_b32 v89, 16, v89
    v_cvt_u32_f32 v89, v89
    v_cvt_u32_f32 v90, v90
    v_lshrrev_b32 v91, 2, v89
    v_add_u32 v91, 384, v91
    v_min_u32 v91, v89, v91
    v_xor_b32 v91, 0x200, v91
    v_lshl_add_u32 v116, v91, 1, s77
    v_lshrrev_b32 v91, 2, v90
    v_add_u32 v91, 384, v91
    v_min_u32 v91, v90, v91
    v_xor_b32 v91, 0x200, v91
    v_lshl_add_u32 v117, v91, 1, s77
    v_add_f32 v89, 0x40400000, v88
    v_add_f32 v90, 0x40800000, v88
    v_cvt_pk_bf16_f32 v89, v89, v90
    v_and_b32 v90, 0xffff0000, v89
    v_lshlrev_b32 v89, 16, v89
    v_cvt_u32_f32 v89, v89
    v_cvt_u32_f32 v90, v90
    v_lshrrev_b32 v91, 2, v89
    v_add_u32 v91, 384, v91
    v_min_u32 v91, v89, v91
    v_xor_b32 v91, 0x200, v91
    v_lshl_add_u32 v118, v91, 1, s77
    v_lshrrev_b32 v91, 2, v90
    v_add_u32 v91, 384, v91
    v_min_u32 v91, v90, v91
    v_xor_b32 v91, 0x200, v91
    v_lshl_add_u32 v119, v91, 1, s77
    v_add_f32 v89, 0x40a00000, v88
    v_add_f32 v90, 0x40c00000, v88
    v_cvt_pk_bf16_f32 v89, v89, v90
    v_and_b32 v90, 0xffff0000, v89
    v_lshlrev_b32 v89, 16, v89
    v_cvt_u32_f32 v89, v89
    v_cvt_u32_f32 v90, v90
    v_lshrrev_b32 v91, 2, v89
    v_add_u32 v91, 384, v91
    v_min_u32 v91, v89, v91
    v_xor_b32 v91, 0x200, v91
    v_lshl_add_u32 v120, v91, 1, s77
    v_lshrrev_b32 v91, 2, v90
    v_add_u32 v91, 384, v91
    v_min_u32 v91, v90, v91
    v_xor_b32 v91, 0x200, v91
    v_lshl_add_u32 v121, v91, 1, s77
    v_add_f32 v89, 0x40e00000, v88
    v_add_f32 v90, 0x447f4000, v88
    v_cvt_pk_bf16_f32 v89, v89, v90
    v_and_b32 v90, 0xffff0000, v89
    v_lshlrev_b32 v89, 16, v89
    v_cvt_u32_f32 v89, v89
    v_cvt_u32_f32 v90, v90
    v_lshrrev_b32 v91, 2, v89
    v_add_u32 v91, 384, v91
    v_min_u32 v91, v89, v91
    v_xor_b32 v91, 0x200, v91
    v_lshl_add_u32 v122, v91, 1, s77
    v_lshrrev_b32 v91, 2, v90
    v_add_u32 v91, 384, v91
    v_xor_b32 v91, 0x200, v91
    v_lshl_add_u32 v123, v91, 1, s77
    v_add_f32 v89, 0x44800000, v88
    v_add_f32 v90, 0x44808000, v88
    v_cvt_pk_bf16_f32 v89, v89, v90
    v_and_b32 v90, 0xffff0000, v89
    v_lshlrev_b32 v89, 16, v89
    v_cvt_u32_f32 v89, v89
    v_cvt_u32_f32 v90, v90
    v_lshrrev_b32 v91, 2, v89
    v_add_u32 v91, 384, v91
    v_xor_b32 v91, 0x200, v91
    v_lshl_add_u32 v124, v91, 1, s77
    v_lshrrev_b32 v91, 2, v90
    v_add_u32 v91, 384, v91
    v_xor_b32 v91, 0x200, v91
    v_lshl_add_u32 v125, v91, 1, s77
    v_add_f32 v89, 0x4480a000, v88
    v_add_f32 v90, 0x00000000, v88
    v_cvt_pk_bf16_f32 v89, v89, v90
    v_and_b32 v90, 0xffff0000, v89
    v_lshlrev_b32 v89, 16, v89
    v_cvt_u32_f32 v89, v89
    v_cvt_u32_f32 v90, v90
    v_lshrrev_b32 v91, 2, v89
    v_add_u32 v91, 384, v91
    v_xor_b32 v91, 0x200, v91
    v_lshl_add_u32 v126, v91, 1, s77
    s_waitcnt vmcnt(1)
    s_waitcnt lgkmcnt(0)
    s_mov_b32 s46, s60
    s_mov_b32 s47, s61
    s_mov_b32 s60, 0x3fb8aa3b
    s_mov_b32 s61, 0x32a57060
    s_mov_b32 s62, 0x3f317218
    s_lshl_b32 s10, s13, 4
    s_lshr_b32 s66, s66, s10
    s_lshl_b32 s66, s66, 16
    s_lshr_b32 s79, s79, s10
    s_lshl_b32 s79, s79, 16
    v_and_b32 v156, 0x7fff7fff, v156
    v_and_b32 v157, 0x7fff7fff, v157
    v_pk_max_u16 v156, v156, v157
    v_mov_b32 v16, s66
    v_lshrrev_b32 v157, 16, v156
    v_and_b32 v156, 0xffff, v156
    v_max_u32 v156, v156, v157
    v_lshlrev_b32 v152, 16, v152
    v_lshlrev_b32 v153, 16, v153
    v_lshlrev_b32 v154, 16, v154
    v_lshlrev_b32 v155, 16, v155
    v_mul_f32 v17, s60, v16
    v_mul_f32 v19, s60, v152
    v_max_u32_dpp v156, v156, v156 quad_perm:[1,0,3,2] row_mask:0xf bank_mask:0xf
    v_fma_f32 v18, v16, s60, -v17
    v_fma_f32 v20, v152, s60, -v19
    v_max_u32_dpp v156, v156, v156 quad_perm:[2,3,0,1] row_mask:0xf bank_mask:0xf
    v_fmac_f32 v18, s61, v16
    v_fmac_f32 v20, s61, v152
    v_max_u32_dpp v156, v156, v156 row_half_mirror row_mask:0xf bank_mask:0xf
    v_exp_f32 v17, v17
    v_exp_f32 v19, v19
    v_max_u32_dpp v156, v156, v156 row_mirror row_mask:0xf bank_mask:0xf
    v_mul_f32 v18, s62, v18
    v_mul_f32 v20, s62, v20
    v_fmac_f32 v17, v17, v18
    v_fmac_f32 v19, v19, v20
    v_cvt_pk_bf16_f32 v17, v17, v17
    v_cvt_pk_bf16_f32 v19, v19, v19
    v_and_b32 v16, 0xffff0000, v17
    v_and_b32 v152, 0xffff0000, v19
    v_readlane_b32 s72, v156, 0
    v_readlane_b32 s73, v156, 16
    v_readlane_b32 s74, v156, 32
    v_readlane_b32 s75, v156, 48
    v_mul_f32 v17, v152, v16
    v_mul_f32 v18, v153, v16
    s_max_u32 s72, s72, s73
    s_max_u32 s74, s74, s75
    s_max_u32 s72, s72, s74
    s_lshr_b32 s72, s72, 7
    s_max_u32 s72, s72, 1
    s_min_u32 s72, s72, 250
    s_sub_u32 s73, 253, s72
    s_lshl_b32 s73, s73, 23
    s_add_u32 s74, s72, 2
    s_lshl_b32 s74, s74, 23
    s_mov_b32 s60, s46
    s_mov_b32 s61, s47
    v_mul_f32 v24, 0xbfb8aa3b, v17
    v_mul_f32 v25, 0.15915494, v18
    v_rndne_f32 v17, v25
    v_sub_f32 v25, v25, v17
    ds_write_b32 v12, v24
    ds_write_b32 v12, v25 offset:64
    v_mul_f32 v26, s73, v154
    v_mul_f32 v27, s73, v155
    v_mul_f32 v157, s74, v16
    v_cvt_pk_f16_f32 v28, v26, v27
    v_readfirstlane_b32 s66, v157
    v_mul_f32 v32, 0x43800000, v24
    v_mul_f32 v33, 0x43800000, v25
    v_mul_f32 v36, 0x44000000, v24
    v_mul_f32 v37, 0x44000000, v25
    v_mul_f32 v40, 0x44c00000, v24
    v_mul_f32 v41, 0x44c00000, v25
    v_exp_f32 v32, v32
    v_fract_f32 v33, v33
    v_exp_f32 v36, v36
    v_fract_f32 v37, v37
    v_exp_f32 v40, v40
    v_fract_f32 v41, v41
    v_cos_f32 v34, v33
    v_sin_f32 v35, v33
    v_cos_f32 v38, v37
    v_sin_f32 v39, v37
    v_cos_f32 v42, v41
    v_sin_f32 v43, v41
    v_mul_f32 v34, v32, v34
    v_mul_f32 v35, v32, v35
    v_mul_f32 v38, v36, v38
    v_mul_f32 v39, v36, v39
    v_mul_f32 v42, v40, v42
    v_mul_f32 v43, v40, v43
    v_mul_f32 v32, v27, v35
    v_mul_f32 v33, v27, v34
    v_mul_f32 v36, v27, v39
    v_mul_f32 v37, v27, v38
    v_mul_f32 v40, v27, v43
    v_mul_f32 v41, v27, v42
    v_fma_f32 v32, v26, v34, -v32
    v_fmac_f32 v33, v26, v35
    v_fma_f32 v36, v26, v38, -v36
    v_fmac_f32 v37, v26, v39
    v_fma_f32 v40, v26, v42, -v40
    v_fmac_f32 v41, v26, v43
    v_cvt_pk_f16_f32 v29, v32, v33
    v_cvt_pk_f16_f32 v30, v36, v37
    v_cvt_pk_f16_f32 v31, v40, v41
    ds_write_b32 v12, v28 offset:128
    ds_write_b32 v12, v29 offset:192
    ds_write_b32 v12, v30 offset:256
    ds_write_b32 v12, v31 offset:320
    s_setprio 1
    s_mov_b32 s55, 0
    s_waitcnt vmcnt(0)
    ds_read_b128 v[44:47], v132 offset:0
    ds_read_b128 v[48:51], v132 offset:64
    s_mov_b32 s8, 4
KF_KLOOP:
    s_lshl_b32 s9, s12, 4
    s_or_b32 s9, s9, s8
    s_cmp_lg_u32 s9, 2
    s_cbranch_scc1 KF_NOIH
    v_mov_b32 v88, 0
    s_mov_b32 s83, 400000
    s_branch KF_POLLI_F
KF_POLLI:
    s_sleep 8
KF_POLLI_F:
    buffer_load_dword v89, v88, s[48:51], 0 offen sc1
    s_waitcnt vmcnt(0)
    v_cmp_ne_u32 vcc, 1, v89
    s_sub_u32 s83, s83, 1
    s_cbranch_scc1 KF_POLLI_D
    s_nop 2
    s_cbranch_vccnz KF_POLLI
KF_POLLI_D:
    ds_write_b32 v8, v6 offset:172
KF_NOIH:
    s_waitcnt lgkmcnt(0)
    v_mul_f32 v70, v44, v133
    v_mul_f32 v69, v48, v133
    v_mul_f32 v73, v45, v133
    v_mul_f32 v72, v49, v133
    v_mul_f32 v76, v46, v133
    v_mul_f32 v75, v50, v133
    v_mul_f32 v79, v47, v133
    v_mul_f32 v78, v51, v133
    ds_read_b128 v[52:55], v132 offset:128
    ds_read_b128 v[56:59], v132 offset:192
    ds_read_b128 v[60:63], v132 offset:256
    ds_read_b128 v[64:67], v132 offset:320
    ds_read_b128 v[44:47], v132 offset:384
    ds_read_b128 v[48:51], v132 offset:448
    v_add_u32 v132, 384, v132
    v_exp_f32 v70, v70
    v_cos_f32 v68, v69
    v_sin_f32 v69, v69
    v_exp_f32 v73, v73
    v_cos_f32 v71, v72
    v_sin_f32 v72, v72
    v_exp_f32 v76, v76
    v_cos_f32 v74, v75
    v_sin_f32 v75, v75
    v_exp_f32 v79, v79
    v_cos_f32 v77, v78
    v_sin_f32 v78, v78
    v_mul_f32 v68, v68, v70
    v_mul_f32 v69, v69, v70
    v_mul_f32 v71, v71, v73
    v_mul_f32 v72, v72, v73
    v_mul_f32 v74, v74, v76
    v_mul_f32 v75, v75, v76
    v_mul_f32 v77, v77, v79
    v_mul_f32 v78, v78, v79
    v_cvt_pk_f16_f32 v16, v68, v69
    v_cvt_pk_f16_f32 v17, v71, v72
    v_cvt_pk_f16_f32 v18, v74, v75
    v_cvt_pk_f16_f32 v19, v77, v78
    v_mul_f32 v70, v69, v69
    v_mul_f32 v73, v72, v72
    v_mul_f32 v76, v75, v75
    v_mul_f32 v79, v78, v78
    v_mul_f32 v69, v68, v69 mul:2
    v_mul_f32 v72, v71, v72 mul:2
    v_mul_f32 v75, v74, v75 mul:2
    v_mul_f32 v78, v77, v78 mul:2
    v_fma_f32 v68, v68, v68, -v70
    v_fma_f32 v71, v71, v71, -v73
    v_fma_f32 v74, v74, v74, -v76
    v_fma_f32 v77, v77, v77, -v79
    v_mul_f32 v70, v69, v69
    v_mul_f32 v73, v72, v72
    v_mul_f32 v76, v75, v75
    v_mul_f32 v79, v78, v78
    v_mul_f32 v69, v68, v69 mul:2
    v_mul_f32 v72, v71, v72 mul:2
    v_mul_f32 v75, v74, v75 mul:2
    v_mul_f32 v78, v77, v78 mul:2
    v_fma_f32 v68, v68, v68, -v70
    v_fma_f32 v71, v71, v71, -v73
    v_fma_f32 v74, v74, v74, -v76
    v_fma_f32 v77, v77, v77, -v79
    v_cvt_pk_f16_f32 v20, v68, v69
    v_cvt_pk_f16_f32 v21, v71, v72
    v_cvt_pk_f16_f32 v22, v74, v75
    v_cvt_pk_f16_f32 v23, v77, v78
    v_mul_f32 v70, v69, v69
    v_mul_f32 v73, v72, v72
    v_mul_f32 v76, v75, v75
    v_mul_f32 v79, v78, v78
    v_mul_f32 v69, v68, v69 mul:2
    v_mul_f32 v72, v71, v72 mul:2
    v_mul_f32 v75, v74, v75 mul:2
    v_mul_f32 v78, v77, v78 mul:2
    v_fma_f32 v68, v68, v68, -v70
    v_fma_f32 v71, v71, v71, -v73
    v_fma_f32 v74, v74, v74, -v76
    v_fma_f32 v77, v77, v77, -v79
    v_mul_f32 v70, v69, v69
    v_mul_f32 v73, v72, v72
    v_mul_f32 v76, v75, v75
    v_mul_f32 v79, v78, v78
    v_mul_f32 v69, v68, v69 mul:2
    v_mul_f32 v72, v71, v72 mul:2
    v_mul_f32 v75, v74, v75 mul:2
    v_mul_f32 v78, v77, v78 mul:2
    v_fma_f32 v68, v68, v68, -v70
    v_fma_f32 v71, v71, v71, -v73
    v_fma_f32 v74, v74, v74, -v76
    v_fma_f32 v77, v77, v77, -v79
    v_cvt_pk_f16_f32 v24, v68, v69
    v_cvt_pk_f16_f32 v25, v71, v72
    v_cvt_pk_f16_f32 v26, v74, v75
    v_cvt_pk_f16_f32 v27, v77, v78
    s_waitcnt lgkmcnt(0)
    v_pk_mul_f16 v28, v52, v24 op_sel:[1,1] op_sel_hi:[1,0]
    v_pk_mul_f16 v29, v53, v25 op_sel:[1,1] op_sel_hi:[1,0]
    v_pk_mul_f16 v30, v54, v26 op_sel:[1,1] op_sel_hi:[1,0]
    v_pk_mul_f16 v31, v55, v27 op_sel:[1,1] op_sel_hi:[1,0]
    v_pk_fma_f16 v28, v52, v24, v28 op_sel:[0,0,0] op_sel_hi:[0,1,1] neg_lo:[0,0,1] neg_hi:[1,0,1]
    v_pk_fma_f16 v29, v53, v25, v29 op_sel:[0,0,0] op_sel_hi:[0,1,1] neg_lo:[0,0,1] neg_hi:[1,0,1]
    v_pk_fma_f16 v30, v54, v26, v30 op_sel:[0,0,0] op_sel_hi:[0,1,1] neg_lo:[0,0,1] neg_hi:[1,0,1]
    v_pk_fma_f16 v31, v55, v27, v31 op_sel:[0,0,0] op_sel_hi:[0,1,1] neg_lo:[0,0,1] neg_hi:[1,0,1]
    v_pk_mul_f16 v32, v56, v24 op_sel:[1,1] op_sel_hi:[1,0]
    v_pk_mul_f16 v33, v57, v25 op_sel:[1,1] op_sel_hi:[1,0]
    v_pk_mul_f16 v34, v58, v26 op_sel:[1,1] op_sel_hi:[1,0]
    v_pk_mul_f16 v35, v59, v27 op_sel:[1,1] op_sel_hi:[1,0]
    v_pk_fma_f16 v32, v56, v24, v32 op_sel:[0,0,0] op_sel_hi:[0,1,1] neg_lo:[0,0,1] neg_hi:[1,0,1]
    v_pk_fma_f16 v33, v57, v25, v33 op_sel:[0,0,0] op_sel_hi:[0,1,1] neg_lo:[0,0,1] neg_hi:[1,0,1]
    v_pk_fma_f16 v34, v58, v26, v34 op_sel:[0,0,0] op_sel_hi:[0,1,1] neg_lo:[0,0,1] neg_hi:[1,0,1]
    v_pk_fma_f16 v35, v59, v27, v35 op_sel:[0,0,0] op_sel_hi:[0,1,1] neg_lo:[0,0,1] neg_hi:[1,0,1]
    v_mul_f32 v70, v69, v69
    v_mul_f32 v73, v72, v72
    v_mul_f32 v76, v75, v75
    v_mul_f32 v79, v78, v78
    v_mul_f32 v69, v68, v69 mul:2
    v_mul_f32 v72, v71, v72 mul:2
    v_mul_f32 v75, v74, v75 mul:2
    v_mul_f32 v78, v77, v78 mul:2
    v_fma_f32 v68, v68, v68, -v70
    v_fma_f32 v71, v71, v71, -v73
    v_fma_f32 v74, v74, v74, -v76
    v_fma_f32 v77, v77, v77, -v79
    v_mfma_f32_16x16x32_f16 v[136:139], v[16:19], v[28:31], v[136:139]
    v_mfma_f32_16x16x32_f16 v[140:143], v[16:19], v[32:35], v[140:143]
    v_mul_f32 v70, v69, v69
    v_mul_f32 v73, v72, v72
    v_mul_f32 v76, v75, v75
    v_mul_f32 v79, v78, v78
    v_mul_f32 v69, v68, v69 mul:2
    v_mul_f32 v72, v71, v72 mul:2
    v_mul_f32 v75, v74, v75 mul:2
    v_mul_f32 v78, v77, v78 mul:2
    v_fma_f32 v68, v68, v68, -v70
    v_fma_f32 v71, v71, v71, -v73
    v_fma_f32 v74, v74, v74, -v76
    v_fma_f32 v77, v77, v77, -v79
    v_cvt_pk_f16_f32 v24, v68, v69
    v_cvt_pk_f16_f32 v25, v71, v72
    v_cvt_pk_f16_f32 v26, v74, v75
    v_cvt_pk_f16_f32 v27, v77, v78
    v_pk_mul_f16 v36, v60, v24 op_sel:[1,1] op_sel_hi:[1,0]
    v_pk_mul_f16 v37, v61, v25 op_sel:[1,1] op_sel_hi:[1,0]
    v_pk_mul_f16 v38, v62, v26 op_sel:[1,1] op_sel_hi:[1,0]
    v_pk_mul_f16 v39, v63, v27 op_sel:[1,1] op_sel_hi:[1,0]
    v_pk_fma_f16 v36, v60, v24, v36 op_sel:[0,0,0] op_sel_hi:[0,1,1] neg_lo:[0,0,1] neg_hi:[1,0,1]
    v_pk_fma_f16 v37, v61, v25, v37 op_sel:[0,0,0] op_sel_hi:[0,1,1] neg_lo:[0,0,1] neg_hi:[1,0,1]
    v_pk_fma_f16 v38, v62, v26, v38 op_sel:[0,0,0] op_sel_hi:[0,1,1] neg_lo:[0,0,1] neg_hi:[1,0,1]
    v_pk_fma_f16 v39, v63, v27, v39 op_sel:[0,0,0] op_sel_hi:[0,1,1] neg_lo:[0,0,1] neg_hi:[1,0,1]
    v_pk_mul_f16 v40, v64, v24 op_sel:[1,1] op_sel_hi:[1,0]
    v_pk_mul_f16 v41, v65, v25 op_sel:[1,1] op_sel_hi:[1,0]
    v_pk_mul_f16 v42, v66, v26 op_sel:[1,1] op_sel_hi:[1,0]
    v_pk_mul_f16 v43, v67, v27 op_sel:[1,1] op_sel_hi:[1,0]
    v_pk_fma_f16 v40, v64, v24, v40 op_sel:[0,0,0] op_sel_hi:[0,1,1] neg_lo:[0,0,1] neg_hi:[1,0,1]
    v_pk_fma_f16 v41, v65, v25, v41 op_sel:[0,0,0] op_sel_hi:[0,1,1] neg_lo:[0,0,1] neg_hi:[1,0,1]
    v_pk_fma_f16 v42, v66, v26, v42 op_sel:[0,0,0] op_sel_hi:[0,1,1] neg_lo:[0,0,1] neg_hi:[1,0,1]
    v_pk_fma_f16 v43, v67, v27, v43 op_sel:[0,0,0] op_sel_hi:[0,1,1] neg_lo:[0,0,1] neg_hi:[1,0,1]
    s_sub_u32 s8, s8, 1
    s_cmp_lg_u32 s8, 0
    v_mfma_f32_16x16x32_f16 v[144:147], v[20:23], v[36:39], v[144:147]
    v_mfma_f32_16x16x32_f16 v[148:151], v[20:23], v[40:43], v[148:151]
    s_cbranch_scc1 KF_KLOOP
    s_setprio 2
    s_xor_b32 s76, s12, 1
    s_mul_i32 s76, s76, 2048
    s_add_u32 s76, s76, 151552
    v_add_u32 v12, s64, v11
    v_add_u32 v13, s76, v11
    v_xor_b32 v5, 4, v7
    s_cmp_eq_u32 s14, 0
    s_cbranch_scc1 KF_NOSWAP
    v_swap_b32 v136, v144
    v_swap_b32 v137, v145
    v_swap_b32 v138, v146
    v_swap_b32 v139, v147
    v_swap_b32 v140, v148
    v_swap_b32 v141, v149
    v_swap_b32 v142, v150
    v_swap_b32 v143, v151
KF_NOSWAP:
    ds_write_b128 v12, v[144:147] offset:0
    ds_write_b128 v12, v[148:151] offset:1024
    ds_write_b32 v7, v6 offset:32
    s_lshl_b32 s8, s14, 10
    s_add_u32 s8, s8, s76
    v_lshlrev_b32 v15, 3, v10
    v_lshl_add_u32 v15, v9, 5, v15
    v_add_u32 v14, s8, v15
SPIN_91:
    ds_read_b32 v16, v5 offset:32
    s_waitcnt lgkmcnt(0)
    v_readfirstlane_b32 s10, v16
    s_nop 0
    s_cmp_eq_u32 s10, 0
    s_cbranch_scc1 SPIN_91
    ds_read_b128 v[16:19], v13 offset:0
    ds_read_b128 v[20:23], v13 offset:1024
    s_waitcnt lgkmcnt(0)
    v_add_f32 v136, v136, v16
    v_add_f32 v137, v137, v17
    v_add_f32 v138, v138, v18
    v_add_f32 v139, v139, v19
    v_cvt_pk_f16_f32 v24, v136, v137
    v_cvt_pk_f16_f32 v25, v138, v139
    ds_write_b64 v14, v[24:25] offset:0
    v_add_f32 v140, v140, v20
    v_add_f32 v141, v141, v21
    v_add_f32 v142, v142, v22
    v_add_f32 v143, v143, v23
    v_cvt_pk_f16_f32 v26, v140, v141
    v_cvt_pk_f16_f32 v27, v142, v143
    ds_write_b64 v14, v[26:27] offset:512
    ds_write_b32 v7, v6 offset:64
    s_mul_i32 s64, s13, 21248
    s_add_u32 s64, s64, 49152
    v_add_u32 v17, 16640, v11
    v_bfe_u32 v18, v0, 1, 2
    v_mul_u32_u24 v18, 4160, v18
    v_and_b32 v19, 1, v0
    v_lshl_add_u32 v18, v19, 4, v18
    v_cmp_gt_u32 vcc, 32, v0
    s_nop 1
    v_cndmask_b32 v17, v18, v17, vcc
    v_add_u32 v148, s64, v17
    s_lshl_b32 s10, s14, 8
    v_lshrrev_b32 v19, 2, v9
    v_mul_u32_u24 v19, 4160, v19
    v_and_b32 v18, 3, v9
    v_lshl_add_u32 v19, v18, 3, v19
    v_lshlrev_b32 v18, 4, v10
    v_sub_u32 v19, v19, v18
    s_add_u32 s8, s64, 312
    s_sub_u32 s8, s8, s10
    v_add_u32 v144, s8, v19
    v_lshl_add_u32 v19, v9, 5, v18
    s_add_u32 s8, s64, 16640
    s_add_u32 s8, s8, s10
    v_add_u32 v145, s8, v19
    v_mov_b32 v147, v15
    s_add_u32 s8, s64, 17120
    s_lshl_b32 s10, s14, 11
    s_add_u32 s75, s8, s10
    v_add_u32 v146, s75, v147
    s_lshl_b32 s8, s14, 10
    s_add_u32 s8, s8, s64
    s_add_u32 s8, s8, 32
    v_add_u32 v149, s8, v11
SPIN_92:
    ds_read_b32 v16, v5 offset:64
    s_waitcnt lgkmcnt(0)
    v_readfirstlane_b32 s10, v16
    s_nop 0
    s_cmp_eq_u32 s10, 0
    s_cbranch_scc1 SPIN_92
    ds_read_u16 v112, v112
    ds_read_u16 v113, v113
    ds_read_u16 v114, v114
    ds_read_u16 v115, v115
    ds_read_u16 v116, v116
    ds_read_u16 v117, v117
    ds_read_u16 v118, v118
    ds_read_u16 v119, v119
    ds_read_u16 v120, v120
    ds_read_u16 v121, v121
    ds_read_u16 v122, v122
    ds_read_u16 v123, v123
    ds_read_u16 v124, v124
    ds_read_u16 v125, v125
    ds_read_u16 v126, v126
    v_cmp_eq_u32 vcc, 0, v0
    s_cmp_eq_u32 s14, 0
    s_cselect_b64 vcc, vcc, 0
    s_waitcnt lgkmcnt(0)
    v_cndmask_b32 v112, v112, 0, vcc
    v_cndmask_b32 v113, v113, 0, vcc
    v_cndmask_b32 v114, v114, 0, vcc
    v_lshl_or_b32 v48, v116, 16, v115
    v_lshl_or_b32 v49, v118, 16, v117
    v_lshl_or_b32 v50, v120, 16, v119
    v_lshl_or_b32 v51, v122, 16, v121
    v_lshl_or_b32 v52, v115, 16, v114
    v_lshl_or_b32 v53, v117, 16, v116
    v_lshl_or_b32 v54, v119, 16, v118
    v_lshl_or_b32 v55, v121, 16, v120
    v_lshl_or_b32 v56, v114, 16, v113
    v_lshl_or_b32 v57, v116, 16, v115
    v_lshl_or_b32 v58, v118, 16, v117
    v_lshl_or_b32 v59, v120, 16, v119
    v_lshl_or_b32 v60, v113, 16, v112
    v_lshl_or_b32 v61, v115, 16, v114
    v_lshl_or_b32 v62, v117, 16, v116
    v_lshl_or_b32 v63, v119, 16, v118
    v_lshl_or_b32 v64, v124, 16, v124
    v_lshl_or_b32 v65, v124, 16, v124
    v_lshl_or_b32 v66, v126, 16, v125
    v_lshl_or_b32 v67, v126, 16, v126
    v_lshl_or_b32 v68, v124, 16, v124
    v_lshl_or_b32 v69, v124, 16, v124
    v_lshl_or_b32 v70, v125, 16, v124
    v_lshl_or_b32 v71, v126, 16, v126
    v_lshl_or_b32 v72, v124, 16, v124
    v_lshl_or_b32 v73, v124, 16, v124
    v_lshl_or_b32 v74, v124, 16, v124
    v_lshl_or_b32 v75, v126, 16, v125
    v_lshl_or_b32 v76, v124, 16, v123
    v_lshl_or_b32 v77, v124, 16, v124
    v_lshl_or_b32 v78, v124, 16, v124
    v_lshl_or_b32 v79, v125, 16, v124
    v_mov_b32 v16, 0
    v_mov_b32 v17, 0
    v_mov_b32 v18, 0
    v_mov_b32 v19, 0
    v_mov_b32 v20, 0
    v_mov_b32 v21, 0
    v_mov_b32 v22, 0
    v_mov_b32 v23, 0
    v_mov_b32 v24, 0
    v_mov_b32 v25, 0
    v_mov_b32 v26, 0
    v_mov_b32 v27, 0
    v_mov_b32 v28, 0
    v_mov_b32 v29, 0
    v_mov_b32 v30, 0
    v_mov_b32 v31, 0
    v_mov_b32 v32, 0
    v_mov_b32 v33, 0
    v_mov_b32 v34, 0
    v_mov_b32 v35, 0
    v_mov_b32 v36, 0
    v_mov_b32 v37, 0
    v_mov_b32 v38, 0
    v_mov_b32 v39, 0
    v_mov_b32 v40, 0
    v_mov_b32 v41, 0
    v_mov_b32 v42, 0
    v_mov_b32 v43, 0
    v_mov_b32 v44, 0
    v_mov_b32 v45, 0
    v_mov_b32 v46, 0
    v_mov_b32 v47, 0
    s_setprio 0
    s_cmp_lg_u32 s12, 0
    s_cbranch_scc1 KF_AW1
SPIN_93:
    s_sleep 4
    ds_read_b128 v[88:91], v8 offset:48
    s_waitcnt lgkmcnt(0)
    v_min3_u32 v88, v88, v89, v90
    v_min_u32 v88, v88, v91
    s_nop 0
    v_readfirstlane_b32 s8, v88
    s_nop 0
    s_cmp_lt_u32 s8, 12
    s_cbranch_scc1 SPIN_93
    s_mov_b32 s83, 400000
    s_branch KF_POLLU_F
KF_POLLU:
    s_sleep 8
KF_POLLU_F:
    buffer_load_dword v89, v4, s[56:59], s52 offen sc1
    s_waitcnt vmcnt(0)
    v_cmp_ne_u32 vcc, 1, v89
    s_sub_u32 s83, s83, 1
    s_cbranch_scc1 KF_POLLU_D
    s_nop 2
    s_cbranch_vccnz KF_POLLU
KF_POLLU_D:
    ds_write_b32 v8, v6 offset:180
KF_AW1:
SPIN_94:
    s_sleep 4
    ds_read_b32 v88, v8 offset:180
    s_waitcnt lgkmcnt(0)
    v_readfirstlane_b32 s8, v88
    s_nop 0
    s_cmp_eq_u32 s8, 0
    s_cbranch_scc1 SPIN_94
    s_lshl_b32 s11, s15, 12
    s_lshl_b32 s10, s14, 11
    s_add_u32 s11, s11, s10
    s_add_u32 s11, s11, 8388608
    buffer_load_dwordx4 v[88:91], v11, s[56:59], s11 offen offset:0 sc1
    buffer_load_dwordx4 v[92:95], v11, s[56:59], s11 offen offset:1024 sc1
    v_add_u32 v96, s75, v11
SPIN_95:
    s_sleep 1
    ds_read_b128 v[100:103], v8 offset:48
    s_waitcnt lgkmcnt(0)
    v_min3_u32 v100, v100, v101, v102
    v_min_u32 v100, v100, v103
    s_nop 0
    v_readfirstlane_b32 s8, v100
    s_nop 0
    s_cmp_lt_u32 s8, 16
    s_cbranch_scc1 SPIN_95
    s_setprio 2
    ds_write_b128 v149, v[48:51] offset:0
    ds_write_b128 v149, v[52:55] offset:4160
    ds_write_b128 v149, v[56:59] offset:8320
    ds_write_b128 v149, v[60:63] offset:12480
    ds_write_b128 v149, v[64:67] offset:2048
    ds_write_b128 v149, v[68:71] offset:6208
    ds_write_b128 v149, v[72:75] offset:10368
    ds_write_b128 v149, v[76:79] offset:14528
    s_mov_b32 exec_lo, 0x3fffffff
    s_mov_b32 exec_hi, 0xff
    ds_write_b128 v148, v[16:19]
    s_mov_b64 exec, -1
    s_waitcnt vmcnt(0)
    ds_write_b128 v96, v[88:91] offset:0
    ds_write_b128 v96, v[92:95] offset:1024
    ds_write_b32 v7, v6 offset:96
SPIN_96:
    ds_read_b32 v100, v5 offset:96
    s_waitcnt lgkmcnt(0)
    v_readfirstlane_b32 s8, v100
    s_nop 0
    s_cmp_eq_u32 s8, 0
    s_cbranch_scc1 SPIN_96
    s_setprio 0
SPIN_97:
    s_sleep 1
    ds_read_b32 v100, v7 offset:192
    s_waitcnt lgkmcnt(0)
    v_readfirstlane_b32 s8, v100
    s_nop 0
    s_cmp_eq_u32 s8, 0
    s_cbranch_scc1 SPIN_97
    s_setprio 2
    ds_read_b128 v[112:115], v145 offset:0
    ds_read_b64_tr_b16 v[76:77], v144 offset:3784
    ds_read_b64_tr_b16 v[78:79], v144 offset:3776
    ds_read_b64_tr_b16 v[72:73], v144 offset:3272
    ds_read_b64_tr_b16 v[74:75], v144 offset:3264
    ds_read_b64_tr_b16 v[68:69], v144 offset:2760
    ds_read_b64_tr_b16 v[70:71], v144 offset:2752
    ds_read_b64_tr_b16 v[64:65], v144 offset:2248
    ds_read_b64_tr_b16 v[66:67], v144 offset:2240
    ds_read_b64_tr_b16 v[60:61], v144 offset:1736
    ds_read_b64_tr_b16 v[62:63], v144 offset:1728
    ds_read_b64_tr_b16 v[56:57], v144 offset:1224
    ds_read_b64_tr_b16 v[58:59], v144 offset:1216
    ds_read_b64_tr_b16 v[52:53], v144 offset:712
    ds_read_b64_tr_b16 v[54:55], v144 offset:704
    ds_read_b64_tr_b16 v[48:49], v144 offset:200
    ds_read_b64_tr_b16 v[50:51], v144 offset:192
    ds_read_b128 v[116:119], v145 offset:512
    ds_read_b128 v[120:123], v145 offset:1024
    ds_read_b128 v[124:127], v145 offset:1536
    ds_read_b128 v[128:131], v145 offset:2048
    ds_read_b128 v[132:135], v145 offset:2560
    ds_read_b128 v[136:139], v145 offset:3072
    ds_read_b128 v[140:143], v145 offset:3584
    s_waitcnt lgkmcnt(15)
    v_mfma_f32_16x16x32_f16 v[44:47], v[76:79], v[112:115], v[44:47]
    ds_read_b64_tr_b16 v[108:109], v144 offset:3720
    s_waitcnt lgkmcnt(15)
    v_mfma_f32_16x16x32_f16 v[40:43], v[72:75], v[112:115], v[40:43]
    ds_read_b64_tr_b16 v[110:111], v144 offset:3712
    s_waitcnt lgkmcnt(15)
    v_mfma_f32_16x16x32_f16 v[36:39], v[68:71], v[112:115], v[36:39]
    ds_read_b64_tr_b16 v[104:105], v144 offset:3208
    s_waitcnt lgkmcnt(15)
    v_mfma_f32_16x16x32_f16 v[32:35], v[64:67], v[112:115], v[32:35]
    ds_read_b64_tr_b16 v[106:107], v144 offset:3200
    s_waitcnt lgkmcnt(15)
    v_mfma_f32_16x16x32_f16 v[28:31], v[60:63], v[112:115], v[28:31]
    ds_read_b64_tr_b16 v[100:101], v144 offset:2696
    s_waitcnt lgkmcnt(15)
    v_mfma_f32_16x16x32_f16 v[24:27], v[56:59], v[112:115], v[24:27]
    ds_read_b64_tr_b16 v[102:103], v144 offset:2688
    s_waitcnt lgkmcnt(15)
    v_mfma_f32_16x16x32_f16 v[20:23], v[52:55], v[112:115], v[20:23]
    ds_read_b64_tr_b16 v[96:97], v144 offset:2184
    s_waitcnt lgkmcnt(14)
    v_mfma_f32_16x16x32_f16 v[16:19], v[48:51], v[112:115], v[16:19]
    ds_read_b128 v[112:115], v145 offset:64
    s_waitcnt lgkmcnt(14)
    v_mfma_f32_16x16x32_f16 v[44:47], v[72:75], v[116:119], v[44:47]
    ds_read_b64_tr_b16 v[98:99], v144 offset:2176
    v_mfma_f32_16x16x32_f16 v[40:43], v[68:71], v[116:119], v[40:43]
    ds_read_b64_tr_b16 v[92:93], v144 offset:1672
    v_mfma_f32_16x16x32_f16 v[36:39], v[64:67], v[116:119], v[36:39]
    ds_read_b64_tr_b16 v[94:95], v144 offset:1664
    v_mfma_f32_16x16x32_f16 v[32:35], v[60:63], v[116:119], v[32:35]
    ds_read_b64_tr_b16 v[88:89], v144 offset:1160
    v_mfma_f32_16x16x32_f16 v[28:31], v[56:59], v[116:119], v[28:31]
    ds_read_b64_tr_b16 v[90:91], v144 offset:1152
    v_mfma_f32_16x16x32_f16 v[24:27], v[52:55], v[116:119], v[24:27]
    ds_read_b64_tr_b16 v[84:85], v144 offset:648
    v_mfma_f32_16x16x32_f16 v[20:23], v[48:51], v[116:119], v[20:23]
    ds_read_b128 v[116:119], v145 offset:576
    s_waitcnt lgkmcnt(15)
    v_mfma_f32_16x16x32_f16 v[44:47], v[68:71], v[120:123], v[44:47]
    ds_read_b64_tr_b16 v[86:87], v144 offset:640
    v_mfma_f32_16x16x32_f16 v[40:43], v[64:67], v[120:123], v[40:43]
    ds_read_b64_tr_b16 v[80:81], v144 offset:136
    v_mfma_f32_16x16x32_f16 v[36:39], v[60:63], v[120:123], v[36:39]
    ds_read_b64_tr_b16 v[82:83], v144 offset:128
    v_mfma_f32_16x16x32_f16 v[32:35], v[56:59], v[120:123], v[32:35]
    v_mfma_f32_16x16x32_f16 v[28:31], v[52:55], v[120:123], v[28:31]
    v_mfma_f32_16x16x32_f16 v[24:27], v[48:51], v[120:123], v[24:27]
    ds_read_b128 v[120:123], v145 offset:1088
    s_waitcnt lgkmcnt(15)
    v_mfma_f32_16x16x32_f16 v[44:47], v[64:67], v[124:127], v[44:47]
    v_mfma_f32_16x16x32_f16 v[40:43], v[60:63], v[124:127], v[40:43]
    v_mfma_f32_16x16x32_f16 v[36:39], v[56:59], v[124:127], v[36:39]
    v_mfma_f32_16x16x32_f16 v[32:35], v[52:55], v[124:127], v[32:35]
    v_mfma_f32_16x16x32_f16 v[28:31], v[48:51], v[124:127], v[28:31]
    ds_read_b128 v[124:127], v145 offset:1600
    s_waitcnt lgkmcnt(15)
    v_mfma_f32_16x16x32_f16 v[44:47], v[60:63], v[128:131], v[44:47]
    v_mfma_f32_16x16x32_f16 v[40:43], v[56:59], v[128:131], v[40:43]
    v_mfma_f32_16x16x32_f16 v[36:39], v[52:55], v[128:131], v[36:39]
    v_mfma_f32_16x16x32_f16 v[32:35], v[48:51], v[128:131], v[32:35]
    ds_read_b128 v[128:131], v145 offset:2112
    s_waitcnt lgkmcnt(15)
    v_mfma_f32_16x16x32_f16 v[44:47], v[56:59], v[132:135], v[44:47]
    v_mfma_f32_16x16x32_f16 v[40:43], v[52:55], v[132:135], v[40:43]
    v_mfma_f32_16x16x32_f16 v[36:39], v[48:51], v[132:135], v[36:39]
    ds_read_b128 v[132:135], v145 offset:2624
    s_waitcnt lgkmcnt(15)
    v_mfma_f32_16x16x32_f16 v[44:47], v[52:55], v[136:139], v[44:47]
    v_mfma_f32_16x16x32_f16 v[40:43], v[48:51], v[136:139], v[40:43]
    ds_read_b128 v[136:139], v145 offset:3136
    s_waitcnt lgkmcnt(15)
    v_mfma_f32_16x16x32_f16 v[44:47], v[48:51], v[140:143], v[44:47]
    ds_read_b128 v[140:143], v145 offset:3648
    s_waitcnt lgkmcnt(15)
    v_mfma_f32_16x16x32_f16 v[44:47], v[108:111], v[112:115], v[44:47]
    ds_read_b64_tr_b16 v[76:77], v144 offset:3656
    v_mfma_f32_16x16x32_f16 v[40:43], v[104:107], v[112:115], v[40:43]
    ds_read_b64_tr_b16 v[78:79], v144 offset:3648
    v_mfma_f32_16x16x32_f16 v[36:39], v[100:103], v[112:115], v[36:39]
    ds_read_b64_tr_b16 v[72:73], v144 offset:3144
    s_waitcnt lgkmcnt(15)
    v_mfma_f32_16x16x32_f16 v[32:35], v[96:99], v[112:115], v[32:35]
    ds_read_b64_tr_b16 v[74:75], v144 offset:3136
    s_waitcnt lgkmcnt(15)
    v_mfma_f32_16x16x32_f16 v[28:31], v[92:95], v[112:115], v[28:31]
    ds_read_b64_tr_b16 v[68:69], v144 offset:2632
    s_waitcnt lgkmcnt(15)
    v_mfma_f32_16x16x32_f16 v[24:27], v[88:91], v[112:115], v[24:27]
    ds_read_b64_tr_b16 v[70:71], v144 offset:2624
    s_waitcnt lgkmcnt(14)
    v_mfma_f32_16x16x32_f16 v[20:23], v[84:87], v[112:115], v[20:23]
    ds_read_b64_tr_b16 v[64:65], v144 offset:2120
    s_waitcnt lgkmcnt(13)
    v_mfma_f32_16x16x32_f16 v[16:19], v[80:83], v[112:115], v[16:19]
    ds_read_b128 v[112:115], v145 offset:128
    v_mfma_f32_16x16x32_f16 v[44:47], v[104:107], v[116:119], v[44:47]
    ds_read_b64_tr_b16 v[66:67], v144 offset:2112
    v_mfma_f32_16x16x32_f16 v[40:43], v[100:103], v[116:119], v[40:43]
    ds_read_b64_tr_b16 v[60:61], v144 offset:1608
    v_mfma_f32_16x16x32_f16 v[36:39], v[96:99], v[116:119], v[36:39]
    ds_read_b64_tr_b16 v[62:63], v144 offset:1600
    v_mfma_f32_16x16x32_f16 v[32:35], v[92:95], v[116:119], v[32:35]
    ds_read_b64_tr_b16 v[56:57], v144 offset:1096
    v_mfma_f32_16x16x32_f16 v[28:31], v[88:91], v[116:119], v[28:31]
    ds_read_b64_tr_b16 v[58:59], v144 offset:1088
    v_mfma_f32_16x16x32_f16 v[24:27], v[84:87], v[116:119], v[24:27]
    ds_read_b64_tr_b16 v[52:53], v144 offset:584
    v_mfma_f32_16x16x32_f16 v[20:23], v[80:83], v[116:119], v[20:23]
    ds_read_b128 v[116:119], v145 offset:640
    s_waitcnt lgkmcnt(15)
    v_mfma_f32_16x16x32_f16 v[44:47], v[100:103], v[120:123], v[44:47]
    ds_read_b64_tr_b16 v[54:55], v144 offset:576
    v_mfma_f32_16x16x32_f16 v[40:43], v[96:99], v[120:123], v[40:43]
    ds_read_b64_tr_b16 v[48:49], v144 offset:72
    v_mfma_f32_16x16x32_f16 v[36:39], v[92:95], v[120:123], v[36:39]
    ds_read_b64_tr_b16 v[50:51], v144 offset:64
    v_mfma_f32_16x16x32_f16 v[32:35], v[88:91], v[120:123], v[32:35]
    v_mfma_f32_16x16x32_f16 v[28:31], v[84:87], v[120:123], v[28:31]
    v_mfma_f32_16x16x32_f16 v[24:27], v[80:83], v[120:123], v[24:27]
    ds_read_b128 v[120:123], v145 offset:1152
    s_waitcnt lgkmcnt(15)
    v_mfma_f32_16x16x32_f16 v[44:47], v[96:99], v[124:127], v[44:47]
    v_mfma_f32_16x16x32_f16 v[40:43], v[92:95], v[124:127], v[40:43]
    v_mfma_f32_16x16x32_f16 v[36:39], v[88:91], v[124:127], v[36:39]
    v_mfma_f32_16x16x32_f16 v[32:35], v[84:87], v[124:127], v[32:35]
    v_mfma_f32_16x16x32_f16 v[28:31], v[80:83], v[124:127], v[28:31]
    ds_read_b128 v[124:127], v145 offset:1664
    s_waitcnt lgkmcnt(15)
    v_mfma_f32_16x16x32_f16 v[44:47], v[92:95], v[128:131], v[44:47]
    v_mfma_f32_16x16x32_f16 v[40:43], v[88:91], v[128:131], v[40:43]
    v_mfma_f32_16x16x32_f16 v[36:39], v[84:87], v[128:131], v[36:39]
    v_mfma_f32_16x16x32_f16 v[32:35], v[80:83], v[128:131], v[32:35]
    ds_read_b128 v[128:131], v145 offset:2176
    s_waitcnt lgkmcnt(15)
    v_mfma_f32_16x16x32_f16 v[44:47], v[88:91], v[132:135], v[44:47]
    v_mfma_f32_16x16x32_f16 v[40:43], v[84:87], v[132:135], v[40:43]
    v_mfma_f32_16x16x32_f16 v[36:39], v[80:83], v[132:135], v[36:39]
    ds_read_b128 v[132:135], v145 offset:2688
    s_waitcnt lgkmcnt(15)
    v_mfma_f32_16x16x32_f16 v[44:47], v[84:87], v[136:139], v[44:47]
    v_mfma_f32_16x16x32_f16 v[40:43], v[80:83], v[136:139], v[40:43]
    ds_read_b128 v[136:139], v145 offset:3200
    s_waitcnt lgkmcnt(15)
    v_mfma_f32_16x16x32_f16 v[44:47], v[80:83], v[140:143], v[44:47]
    ds_read_b128 v[140:143], v145 offset:3712
    s_waitcnt lgkmcnt(15)
    v_mfma_f32_16x16x32_f16 v[44:47], v[76:79], v[112:115], v[44:47]
    ds_read_b64_tr_b16 v[108:109], v144 offset:3592
    v_mfma_f32_16x16x32_f16 v[40:43], v[72:75], v[112:115], v[40:43]
    ds_read_b64_tr_b16 v[110:111], v144 offset:3584
    v_mfma_f32_16x16x32_f16 v[36:39], v[68:71], v[112:115], v[36:39]
    ds_read_b64_tr_b16 v[104:105], v144 offset:3080
    s_waitcnt lgkmcnt(15)
    v_mfma_f32_16x16x32_f16 v[32:35], v[64:67], v[112:115], v[32:35]
    ds_read_b64_tr_b16 v[106:107], v144 offset:3072
    s_waitcnt lgkmcnt(15)
    v_mfma_f32_16x16x32_f16 v[28:31], v[60:63], v[112:115], v[28:31]
    ds_read_b64_tr_b16 v[100:101], v144 offset:2568
    s_waitcnt lgkmcnt(15)
    v_mfma_f32_16x16x32_f16 v[24:27], v[56:59], v[112:115], v[24:27]
    ds_read_b64_tr_b16 v[102:103], v144 offset:2560
    s_waitcnt lgkmcnt(14)
    v_mfma_f32_16x16x32_f16 v[20:23], v[52:55], v[112:115], v[20:23]
    ds_read_b64_tr_b16 v[96:97], v144 offset:2056
    s_waitcnt lgkmcnt(13)
    v_mfma_f32_16x16x32_f16 v[16:19], v[48:51], v[112:115], v[16:19]
    ds_read_b128 v[112:115], v145 offset:192
    v_mfma_f32_16x16x32_f16 v[44:47], v[72:75], v[116:119], v[44:47]
    ds_read_b64_tr_b16 v[98:99], v144 offset:2048
    v_mfma_f32_16x16x32_f16 v[40:43], v[68:71], v[116:119], v[40:43]
    ds_read_b64_tr_b16 v[92:93], v144 offset:1544
    v_mfma_f32_16x16x32_f16 v[36:39], v[64:67], v[116:119], v[36:39]
    ds_read_b64_tr_b16 v[94:95], v144 offset:1536
    v_mfma_f32_16x16x32_f16 v[32:35], v[60:63], v[116:119], v[32:35]
    ds_read_b64_tr_b16 v[88:89], v144 offset:1032
    v_mfma_f32_16x16x32_f16 v[28:31], v[56:59], v[116:119], v[28:31]
    ds_read_b64_tr_b16 v[90:91], v144 offset:1024
    v_mfma_f32_16x16x32_f16 v[24:27], v[52:55], v[116:119], v[24:27]
    ds_read_b64_tr_b16 v[84:85], v144 offset:520
    v_mfma_f32_16x16x32_f16 v[20:23], v[48:51], v[116:119], v[20:23]
    ds_read_b128 v[116:119], v145 offset:704
    s_waitcnt lgkmcnt(15)
    v_mfma_f32_16x16x32_f16 v[44:47], v[68:71], v[120:123], v[44:47]
    ds_read_b64_tr_b16 v[86:87], v144 offset:512
    v_mfma_f32_16x16x32_f16 v[40:43], v[64:67], v[120:123], v[40:43]
    ds_read_b64_tr_b16 v[80:81], v144 offset:8
    v_mfma_f32_16x16x32_f16 v[36:39], v[60:63], v[120:123], v[36:39]
    ds_read_b64_tr_b16 v[82:83], v144 offset:0
    v_mfma_f32_16x16x32_f16 v[32:35], v[56:59], v[120:123], v[32:35]
    v_mfma_f32_16x16x32_f16 v[28:31], v[52:55], v[120:123], v[28:31]
    v_mfma_f32_16x16x32_f16 v[24:27], v[48:51], v[120:123], v[24:27]
    ds_read_b128 v[120:123], v145 offset:1216
    s_waitcnt lgkmcnt(15)
    v_mfma_f32_16x16x32_f16 v[44:47], v[64:67], v[124:127], v[44:47]
    v_mfma_f32_16x16x32_f16 v[40:43], v[60:63], v[124:127], v[40:43]
    v_mfma_f32_16x16x32_f16 v[36:39], v[56:59], v[124:127], v[36:39]
    v_mfma_f32_16x16x32_f16 v[32:35], v[52:55], v[124:127], v[32:35]
    v_mfma_f32_16x16x32_f16 v[28:31], v[48:51], v[124:127], v[28:31]
    ds_read_b128 v[124:127], v145 offset:1728
    s_waitcnt lgkmcnt(15)
    v_mfma_f32_16x16x32_f16 v[44:47], v[60:63], v[128:131], v[44:47]
    v_mfma_f32_16x16x32_f16 v[40:43], v[56:59], v[128:131], v[40:43]
    v_mfma_f32_16x16x32_f16 v[36:39], v[52:55], v[128:131], v[36:39]
    v_mfma_f32_16x16x32_f16 v[32:35], v[48:51], v[128:131], v[32:35]
    ds_read_b128 v[128:131], v145 offset:2240
    s_waitcnt lgkmcnt(15)
    v_mfma_f32_16x16x32_f16 v[44:47], v[56:59], v[132:135], v[44:47]
    v_mfma_f32_16x16x32_f16 v[40:43], v[52:55], v[132:135], v[40:43]
    v_mfma_f32_16x16x32_f16 v[36:39], v[48:51], v[132:135], v[36:39]
    ds_read_b128 v[132:135], v145 offset:2752
    s_waitcnt lgkmcnt(15)
    v_mfma_f32_16x16x32_f16 v[44:47], v[52:55], v[136:139], v[44:47]
    v_mfma_f32_16x16x32_f16 v[40:43], v[48:51], v[136:139], v[40:43]
    ds_read_b128 v[136:139], v145 offset:3264
    s_waitcnt lgkmcnt(15)
    v_mfma_f32_16x16x32_f16 v[44:47], v[48:51], v[140:143], v[44:47]
    ds_read_b128 v[140:143], v145 offset:3776
    s_waitcnt lgkmcnt(15)
    v_mfma_f32_16x16x32_f16 v[44:47], v[108:111], v[112:115], v[44:47]
    v_mfma_f32_16x16x32_f16 v[40:43], v[104:107], v[112:115], v[40:43]
    v_mfma_f32_16x16x32_f16 v[36:39], v[100:103], v[112:115], v[36:39]
    s_waitcnt lgkmcnt(15)
    v_mfma_f32_16x16x32_f16 v[32:35], v[96:99], v[112:115], v[32:35]
    s_waitcnt lgkmcnt(13)
    v_mfma_f32_16x16x32_f16 v[28:31], v[92:95], v[112:115], v[28:31]
    s_waitcnt lgkmcnt(11)
    v_mfma_f32_16x16x32_f16 v[24:27], v[88:91], v[112:115], v[24:27]
    s_waitcnt lgkmcnt(8)
    v_mfma_f32_16x16x32_f16 v[20:23], v[84:87], v[112:115], v[20:23]
    s_waitcnt lgkmcnt(6)
    v_mfma_f32_16x16x32_f16 v[16:19], v[80:83], v[112:115], v[16:19]
    v_mfma_f32_16x16x32_f16 v[44:47], v[104:107], v[116:119], v[44:47]
    v_mfma_f32_16x16x32_f16 v[40:43], v[100:103], v[116:119], v[40:43]
    v_mfma_f32_16x16x32_f16 v[36:39], v[96:99], v[116:119], v[36:39]
    v_mfma_f32_16x16x32_f16 v[32:35], v[92:95], v[116:119], v[32:35]
    v_mfma_f32_16x16x32_f16 v[28:31], v[88:91], v[116:119], v[28:31]
    v_mfma_f32_16x16x32_f16 v[24:27], v[84:87], v[116:119], v[24:27]
    v_mfma_f32_16x16x32_f16 v[20:23], v[80:83], v[116:119], v[20:23]
    s_waitcnt lgkmcnt(5)
    v_mfma_f32_16x16x32_f16 v[44:47], v[100:103], v[120:123], v[44:47]
    v_mfma_f32_16x16x32_f16 v[40:43], v[96:99], v[120:123], v[40:43]
    v_mfma_f32_16x16x32_f16 v[36:39], v[92:95], v[120:123], v[36:39]
    v_mfma_f32_16x16x32_f16 v[32:35], v[88:91], v[120:123], v[32:35]
    v_mfma_f32_16x16x32_f16 v[28:31], v[84:87], v[120:123], v[28:31]
    v_mfma_f32_16x16x32_f16 v[24:27], v[80:83], v[120:123], v[24:27]
    s_waitcnt lgkmcnt(4)
    v_mfma_f32_16x16x32_f16 v[44:47], v[96:99], v[124:127], v[44:47]
    v_mfma_f32_16x16x32_f16 v[40:43], v[92:95], v[124:127], v[40:43]
    v_mfma_f32_16x16x32_f16 v[36:39], v[88:91], v[124:127], v[36:39]
    v_mfma_f32_16x16x32_f16 v[32:35], v[84:87], v[124:127], v[32:35]
    v_mfma_f32_16x16x32_f16 v[28:31], v[80:83], v[124:127], v[28:31]
    s_waitcnt lgkmcnt(3)
    v_mfma_f32_16x16x32_f16 v[44:47], v[92:95], v[128:131], v[44:47]
    v_mfma_f32_16x16x32_f16 v[40:43], v[88:91], v[128:131], v[40:43]
    v_mfma_f32_16x16x32_f16 v[36:39], v[84:87], v[128:131], v[36:39]
    v_mfma_f32_16x16x32_f16 v[32:35], v[80:83], v[128:131], v[32:35]
    s_waitcnt lgkmcnt(2)
    v_mfma_f32_16x16x32_f16 v[44:47], v[88:91], v[132:135], v[44:47]
    v_mfma_f32_16x16x32_f16 v[40:43], v[84:87], v[132:135], v[40:43]
    v_mfma_f32_16x16x32_f16 v[36:39], v[80:83], v[132:135], v[36:39]
    s_waitcnt lgkmcnt(1)
    v_mfma_f32_16x16x32_f16 v[44:47], v[84:87], v[136:139], v[44:47]
    v_mfma_f32_16x16x32_f16 v[40:43], v[80:83], v[136:139], v[40:43]
    s_waitcnt lgkmcnt(0)
    v_mfma_f32_16x16x32_f16 v[44:47], v[80:83], v[140:143], v[44:47]
    s_lshl_b32 s10, s12, 12
    s_add_u32 s10, s10, 92160
    v_add_u32 v96, s10, v11
    s_xor_b32 s74, s12, 1
    s_lshl_b32 s74, s74, 12
    s_add_u32 s74, s74, 92160
    v_add_u32 v97, s74, v11
    s_nop 3
    s_cmp_eq_u32 s14, 0
    s_cbranch_scc1 KF_NOSWAP2
    v_swap_b32 v16, v32
    v_swap_b32 v17, v33
    v_swap_b32 v18, v34
    v_swap_b32 v19, v35
    v_swap_b32 v20, v36
    v_swap_b32 v21, v37
    v_swap_b32 v22, v38
    v_swap_b32 v23, v39
    v_swap_b32 v24, v40
    v_swap_b32 v25, v41
    v_swap_b32 v26, v42
    v_swap_b32 v27, v43
    v_swap_b32 v28, v44
    v_swap_b32 v29, v45
    v_swap_b32 v30, v46
    v_swap_b32 v31, v47
KF_NOSWAP2:
    ds_write_b128 v96, v[32:35] offset:0
    ds_write_b128 v96, v[36:39] offset:1024
    ds_write_b128 v96, v[40:43] offset:2048
    ds_write_b128 v96, v[44:47] offset:3072
    ds_write_b32 v7, v6 offset:112
    ds_read_b64 v[48:49], v146 offset:0
    ds_read_b64 v[50:51], v146 offset:512
    ds_read_b64 v[52:53], v146 offset:1024
    ds_read_b64 v[54:55], v146 offset:1536
    s_lshl_b32 s8, s15, 12
    s_lshl_b32 s10, s14, 11
    s_add_u32 s8, s8, s10
    s_add_u32 s8, s8, 16777216
    v_lshrrev_b32 v98, 1, v10
    v_lshlrev_b32 v98, 4, v98
    v_lshl_add_u32 v98, v9, 5, v98
    v_and_b32 v99, 1, v10
    v_lshl_add_u32 v98, v99, 9, v98
SPIN_98:
    ds_read_b32 v60, v5 offset:112
    s_waitcnt lgkmcnt(0)
    v_readfirstlane_b32 s9, v60
    s_nop 0
    s_cmp_eq_u32 s9, 0
    s_cbranch_scc1 SPIN_98
    ds_read_b128 v[80:83], v97 offset:0
    ds_read_b128 v[84:87], v97 offset:1024
    ds_read_b128 v[88:91], v97 offset:2048
    ds_read_b128 v[92:95], v97 offset:3072
    v_fma_mix_f32 v64, v48, s79, 0 op_sel:[0,0,0] op_sel_hi:[1,0,0]
    v_fma_mix_f32 v65, v48, s79, 0 op_sel:[1,0,0] op_sel_hi:[1,0,0]
    v_fma_mix_f32 v66, v49, s79, 0 op_sel:[0,0,0] op_sel_hi:[1,0,0]
    v_fma_mix_f32 v67, v49, s79, 0 op_sel:[1,0,0] op_sel_hi:[1,0,0]
    v_fma_mix_f32 v68, v50, s79, 0 op_sel:[0,0,0] op_sel_hi:[1,0,0]
    v_fma_mix_f32 v69, v50, s79, 0 op_sel:[1,0,0] op_sel_hi:[1,0,0]
    v_fma_mix_f32 v70, v51, s79, 0 op_sel:[0,0,0] op_sel_hi:[1,0,0]
    v_fma_mix_f32 v71, v51, s79, 0 op_sel:[1,0,0] op_sel_hi:[1,0,0]
    v_fma_mix_f32 v72, v52, s79, 0 op_sel:[0,0,0] op_sel_hi:[1,0,0]
    v_fma_mix_f32 v73, v52, s79, 0 op_sel:[1,0,0] op_sel_hi:[1,0,0]
    v_fma_mix_f32 v74, v53, s79, 0 op_sel:[0,0,0] op_sel_hi:[1,0,0]
    v_fma_mix_f32 v75, v53, s79, 0 op_sel:[1,0,0] op_sel_hi:[1,0,0]
    v_fma_mix_f32 v76, v54, s79, 0 op_sel:[0,0,0] op_sel_hi:[1,0,0]
    v_fma_mix_f32 v77, v54, s79, 0 op_sel:[1,0,0] op_sel_hi:[1,0,0]
    v_fma_mix_f32 v78, v55, s79, 0 op_sel:[0,0,0] op_sel_hi:[1,0,0]
    v_fma_mix_f32 v79, v55, s79, 0 op_sel:[1,0,0] op_sel_hi:[1,0,0]
    s_waitcnt lgkmcnt(3)
    v_add_f32 v16, v16, v80
    v_add_f32 v17, v17, v81
    v_add_f32 v18, v18, v82
    v_add_f32 v19, v19, v83
    v_fmac_f32 v64, s66, v16
    v_fmac_f32 v65, s66, v17
    v_fmac_f32 v66, s66, v18
    v_fmac_f32 v67, s66, v19
    v_cvt_pk_bf16_f32 v48, v64, v65
    v_cvt_pk_bf16_f32 v49, v66, v67
    v_min_u32 v48, -2, v48
    v_min_u32 v49, -2, v49
    s_waitcnt lgkmcnt(2)
    v_add_f32 v20, v20, v84
    v_add_f32 v21, v21, v85
    v_add_f32 v22, v22, v86
    v_add_f32 v23, v23, v87
    v_fmac_f32 v68, s66, v20
    v_fmac_f32 v69, s66, v21
    v_fmac_f32 v70, s66, v22
    v_fmac_f32 v71, s66, v23
    v_cvt_pk_bf16_f32 v50, v68, v69
    v_cvt_pk_bf16_f32 v51, v70, v71
    v_min_u32 v50, -2, v50
    v_min_u32 v51, -2, v51
    s_nop 0
    v_permlane16_swap_b32 v48, v50
    v_permlane16_swap_b32 v49, v51
    buffer_store_dwordx4 v[48:51], v98, s[56:59], s8 offen offset:0 sc1
    s_waitcnt lgkmcnt(1)
    v_add_f32 v24, v24, v88
    v_add_f32 v25, v25, v89
    v_add_f32 v26, v26, v90
    v_add_f32 v27, v27, v91
    v_fmac_f32 v72, s66, v24
    v_fmac_f32 v73, s66, v25
    v_fmac_f32 v74, s66, v26
    v_fmac_f32 v75, s66, v27
    v_cvt_pk_bf16_f32 v52, v72, v73
    v_cvt_pk_bf16_f32 v53, v74, v75
    v_min_u32 v52, -2, v52
    v_min_u32 v53, -2, v53
    s_waitcnt lgkmcnt(0)
    v_add_f32 v28, v28, v92
    v_add_f32 v29, v29, v93
    v_add_f32 v30, v30, v94
    v_add_f32 v31, v31, v95
    v_fmac_f32 v76, s66, v28
    v_fmac_f32 v77, s66, v29
    v_fmac_f32 v78, s66, v30
    v_fmac_f32 v79, s66, v31
    v_cvt_pk_bf16_f32 v54, v76, v77
    v_cvt_pk_bf16_f32 v55, v78, v79
    v_min_u32 v54, -2, v54
    v_min_u32 v55, -2, v55
    s_nop 0
    v_permlane16_swap_b32 v52, v54
    v_permlane16_swap_b32 v53, v55
    buffer_store_dwordx4 v[52:55], v98, s[56:59], s8 offen offset:1024 sc1
    s_setprio 3
    v_lshrrev_b32 v22, 3, v0
    v_and_b32 v23, 7, v0
    v_lshlrev_b32 v24, 12, v22
    v_lshl_add_u32 v24, v23, 4, v24
    v_mul_u32_u24 v25, 144, v22
    v_lshl_add_u32 v25, v23, 4, v25
    v_add_u32 v25, s74, v25
    s_lshl_b32 s9, s68, 18
    s_lshl_b32 s10, s12, 16
    s_add_u32 s9, s9, s10
    s_lshl_b32 s10, s67, 7
    s_add_u32 s9, s9, s10
    s_add_u32 s9, s9, 16777216
    s_add_u32 s10, s9, 0x8000
    s_mov_b32 s54, s9
    s_lshl_b32 s8, s68, 7
    s_add_u32 s8, s8, 0
    v_lshlrev_b32 v2, 4, v10
    v_add_u32 v2, s8, v2
    s_lshl_b32 s8, s67, 6
    s_lshl_b32 s9, s12, 4
    s_add_u32 s8, s8, s9
    v_add_u32 v3, s8, v9
    v_lshl_add_u32 v3, v3, 10, v2
    global_load_dwordx4 v[160:163], v3, s[16:17]
    global_load_dwordx4 v[164:167], v2, s[38:39]
    s_mov_b32 s9, s54
SPIN_99:
    s_sleep 4
    ds_read_b32 v26, v8 offset:188
    s_waitcnt lgkmcnt(0)
    v_readfirstlane_b32 s8, v26
    s_nop 0
    s_cmp_eq_u32 s8, 0
    s_cbranch_scc1 SPIN_99
    s_mov_b32 s83, 400000
    s_branch KF_POLLA_F
KF_POLLA:
    s_sleep 8
KF_POLLA_F:
    buffer_load_dwordx4 v[28:31], v24, s[56:59], s9 offen sc1
    buffer_load_dwordx4 v[32:35], v24, s[56:59], s10 offen sc1
    s_waitcnt vmcnt(0)
    v_max3_u32 v26, v28, v29, v30
    v_max3_u32 v27, v31, v32, v33
    v_max3_u32 v26, v26, v34, v35
    v_max_u32 v26, v26, v27
    v_cmp_eq_u32 vcc, -1, v26
    s_sub_u32 s83, s83, 1
    s_cbranch_scc1 KF_POLLA_D
    s_nop 2
    s_cbranch_vccnz KF_POLLA
KF_POLLA_D:
    ds_write_b128 v25, v[28:31]
    ds_write_b128 v25, v[32:35] offset:1152
    s_mov_b32 s13, 0
    s_branch KF_FINAL
KF_FIN:
KF_END:
    s_endpgm
CODE_END:
.section .rodata,"a"
.p2align 6
.amdhsa_kernel parallel_sum__ssm_conv_s4d__dense_activation_squared_relu__prompt_kernel
  .amdhsa_next_free_vgpr 168
  .amdhsa_next_free_sgpr 102
  .amdhsa_accum_offset 168
  .amdhsa_group_segment_fixed_size 0
  .amdhsa_kernarg_size 120
  .amdhsa_user_sgpr_count 2
  .amdhsa_user_sgpr_kernarg_segment_ptr 1
  .amdhsa_system_sgpr_workgroup_id_x 1
  .amdhsa_ieee_mode 0
.end_amdhsa_kernel
```
